```python
import torch

def _softmax(x, axis=-1):
    return torch.softmax(x, dim=axis)
def _gelu(x):
    return torch.nn.functional.gelu(x, approximate="tanh")
def _silu(x):
    return torch.nn.functional.silu(x)
def _sigmoid(x):
    return torch.sigmoid(x)
def _layernorm(x, axis=-1, eps=1e-5):
    m = x.mean(dim=axis, keepdim=True)
    v = x.var(dim=axis, keepdim=True, unbiased=False)
    return (x - m) / torch.sqrt(v + eps)
def _scatter_add(tgt, idx, src, axis=0):
    return tgt.clone().index_add_(axis, idx, src)
def _segment_sum(src, seg, n):
    out = torch.zeros((n,) + src.shape[1:], dtype=src.dtype)
    return out.index_add_(0, seg, src)
def _pad(x, pw):
    flat = tuple(v for pair in reversed(pw) for v in pair)
    return torch.nn.functional.pad(x, flat)

kernel_name = 'standalone__controlnet__diffusion'

def setup_inputs():

    _w = (lambda a: (lambda t: t.to(torch.bfloat16) if t.is_floating_point() else t)(torch.as_tensor(a)))
    B, HW, C = 2, 128, 128
    sc = C ** -0.5
    return {
        "x_frozen": _w((lambda *s: torch.randn(*s, dtype=torch.bfloat16) * 0.05)(B, HW, HW, C)),
        "x": _w((lambda *s: torch.randn(*s, dtype=torch.bfloat16) * 0.1)(B, HW, HW, C)),
        "c": _w((lambda *s: torch.randn(*s, dtype=torch.bfloat16) * 0.4)(B, HW, HW, C)),
        "w_z1": _w((lambda *s: torch.randn(*s, dtype=torch.bfloat16) * 0.4)(C, C) * sc),
        "w_z2": _w((lambda *s: torch.randn(*s, dtype=torch.bfloat16) * 0.1)(C, C) * sc),
        "w_conv": _w((lambda *s: torch.randn(*s, dtype=torch.bfloat16) * 0.1)(3, 3, C, C) * sc / 3.0),
    }

def reference(x_frozen, x, c, w_z1, w_z2, w_conv):
    B, H, W, C = x.shape
    h_in = x + torch.einsum("bhwc,cd->bhwd", c, w_z1)
    h = _silu(_layernorm(h_in, axis=-1))
    hp = _pad(h, ((0, 0), (1, 1), (1, 1), (0, 0)))
    acc = h * 0.0
    for di in range(3):
        for dj in range(3):
            acc = acc + torch.einsum("bhwc,cd->bhwd", hp[:, di:di + H, dj:dj + W, :], w_conv[di, dj])
    h = h_in + acc
    return x_frozen + torch.einsum("bhwc,cd->bhwd", h, w_z2)
```

```asm
; @launch grid=(256,1,1) block=(256,1,1) lds=162816
.amdgcn_target "amdgcn-amd-amdhsa--gfx950"
.text
.globl standalone__controlnet__diffusion_kernel
.p2align 8
.type standalone__controlnet__diffusion_kernel,@function
standalone__controlnet__diffusion_kernel:
L_start:
  s_cmp_ge_u32 s2, 0x100
  s_cbranch_scc1 L_end
  s_getpc_b64 s[4:5]
L_pc:
  s_lshr_b32 s3, s2, 3
  s_lshl_b32 s3, s3, 10
  v_and_b32 v128, 3, v0
  v_lshrrev_b32 v129, 6, v0
  v_lshl_add_u32 v128, v129, 2, v128
  v_lshl_add_u32 v128, v128, 6, s3
  v_min_u32 v128, L_end-L_pc, v128
  global_load_dword v176, v128, s[4:5]
  s_load_dwordx2 s[16:17], s[0:1], 16
  s_load_dwordx2 s[12:13], s[0:1], 8
  s_load_dwordx2 s[20:21], s[0:1], 24
  s_load_dwordx2 s[28:29], s[0:1], 40
  s_load_dwordx2 s[24:25], s[0:1], 32
  s_load_dwordx2 s[8:9], s[0:1], 0
  s_load_dwordx2 s[32:33], s[0:1], 48
  v_lshrrev_b32 v128, 6, v0
  s_nop 0
  v_readfirstlane_b32 s50, v128
  s_mov_b32 s10, 0x800000
  s_mov_b32 s11, 0x20000
  s_mov_b32 s14, 0x800000
  s_mov_b32 s15, 0x20000
  s_mov_b32 s18, 0x800000
  s_mov_b32 s19, 0x20000
  s_mov_b32 s22, 0x8000
  s_mov_b32 s23, 0x20000
  s_mov_b32 s26, 0x8000
  s_mov_b32 s27, 0x20000
  s_mov_b32 s30, 0x48000
  s_mov_b32 s31, 0x20000
  s_mov_b32 s34, 0x800000
  s_mov_b32 s35, 0x20000
  v_and_b32 v208, 63, v0
  v_and_b32 v209, 31, v0
  v_bfe_u32 v210, v0, 5, 1
  v_and_b32 v211, 15, v0
  v_bfe_u32 v212, v0, 4, 1
  v_bfe_u32 v214, v0, 4, 2
  v_bfe_u32 v213, v0, 2, 4
  s_and_b32 s52, s2, 7
  s_lshr_b32 s53, s2, 3
  s_lshr_b32 s54, s52, 2
  s_and_b32 s55, s52, 3
  s_lshl_b32 s55, s55, 2
  s_lshr_b32 s59, s53, 3
  s_add_u32 s55, s55, s59
  s_and_b32 s56, s53, 7
  s_lshl_b32 s58, s55, 3
  s_lshl_b32 s57, s54, 22
  s_lshl_b32 s59, s58, 15
  s_add_u32 s57, s57, s59
  s_lshl_b32 s59, s56, 12
  s_add_u32 s57, s57, s59
  s_sub_u32 s40, s57, 0x8000
  s_mov_b32 s41, s57
  s_add_u32 s42, s57, 0x8000
  s_add_u32 s43, s57, 0x10000
  s_add_u32 s44, s57, 0x18000
  s_add_u32 s45, s57, 0x20000
  s_add_u32 s46, s57, 0x28000
  s_add_u32 s47, s57, 0x30000
  s_add_u32 s48, s57, 0x38000
  s_add_u32 s49, s57, 0x40000
  s_cmp_eq_u32 s55, 0
  s_cselect_b32 s40, 0x80000000, s40
  s_cmp_eq_u32 s55, 15
  s_cselect_b32 s49, 0x80000000, s49
  s_lshl_b32 s60, s50, 6
  s_lshl_b32 s65, s50, 10
  s_lshl_b32 s3, s50, 2
  v_add_u32 v128, s3, v214
  v_xor_b32 v129, v128, v211
  v_lshlrev_b32 v129, 4, v129
  v_lshl_add_u32 v1, v128, 8, v129
  v_and_b32 v129, 3, v0
  v_lshl_add_u32 v130, v129, 4, s60
  v_lshl_add_u32 v22, v213, 8, v130
  s_mul_i32 s64, s50, 0x3800
  s_add_u32 s64, s64, 0x19c00
  s_lshl_b32 s76, s53, 2
  s_add_u32 s76, s76, s50
  s_waitcnt lgkmcnt(0)
  v_and_b32 v128, 3, v0
  v_lshlrev_b32 v128, 6, v128
  s_lshl_b32 s3, s76, 8
  buffer_load_dword v177, v128, s[20:23], s3 offen
  s_add_u32 m0, s65, 0x8000
  s_nop 0
  buffer_load_dwordx4 v1, s[16:19], s41 offen nt lds
  s_addk_i32 m0, -16384
  s_nop 0
  buffer_load_dwordx4 v1, s[12:15], s41 offen nt lds
  s_addk_i32 m0, 20480
  s_nop 0
  buffer_load_dwordx4 v1, s[16:19], s43 offen nt lds
  s_addk_i32 m0, -16384
  s_nop 0
  buffer_load_dwordx4 v1, s[12:15], s43 offen nt lds
  s_addk_i32 m0, 20480
  s_nop 0
  buffer_load_dwordx4 v1, s[16:19], s42 offen nt lds
  s_addk_i32 m0, -16384
  s_nop 0
  buffer_load_dwordx4 v1, s[12:15], s42 offen nt lds
  s_addk_i32 m0, 20480
  s_nop 0
  buffer_load_dwordx4 v1, s[16:19], s44 offen nt lds
  s_addk_i32 m0, -16384
  s_nop 0
  buffer_load_dwordx4 v1, s[12:15], s44 offen nt lds
  s_sub_u32 s61, s58, 1
  s_lshl_b32 s62, s56, 4
  s_lshl_b32 s63, s54, 22
  s_lshl_b32 s3, s50, 2
  v_add_u32 v128, s3, v214
  v_cmp_le_u32 vcc, 10, v128
  v_subrev_u32 v129, 10, v128
  v_mov_b32 v130, -1
  v_mov_b32 v131, 16
  v_cndmask_b32 v129, v128, v129, vcc
  v_cndmask_b32 v130, v130, v131, vcc
  v_add_u32 v129, s61, v129
  v_add_u32 v130, s62, v130
  v_lshlrev_b32 v131, 15, v129
  v_lshl_add_u32 v131, v130, 8, v131
  v_add_u32 v131, s63, v131
  v_max_u32 v129, v129, v130
  v_lshrrev_b32 v129, 7, v129
  v_subrev_u32 v130, 20, v128
  v_lshrrev_b32 v130, 31, v130
  v_xor_b32 v130, 1, v130
  v_or_b32 v129, v129, v130
  v_cmp_eq_u32 vcc, 0, v129
  v_mov_b32 v130, 0x80000000
  s_nop 0
  v_cndmask_b32 v144, v130, v131, vcc
  v_and_b32 v128, 15, v128
  v_xor_b32 v128, v128, v211
  v_lshl_add_u32 v144, v128, 4, v144
  v_add_u32 v128, s3, v214
  v_add_u32 v128, 16, v128
  v_cmp_le_u32 vcc, 10, v128
  v_subrev_u32 v129, 10, v128
  v_mov_b32 v130, -1
  v_mov_b32 v131, 16
  v_cndmask_b32 v129, v128, v129, vcc
  v_cndmask_b32 v130, v130, v131, vcc
  v_add_u32 v129, s61, v129
  v_add_u32 v130, s62, v130
  v_lshlrev_b32 v131, 15, v129
  v_lshl_add_u32 v131, v130, 8, v131
  v_add_u32 v131, s63, v131
  v_max_u32 v129, v129, v130
  v_lshrrev_b32 v129, 7, v129
  v_subrev_u32 v130, 20, v128
  v_lshrrev_b32 v130, 31, v130
  v_xor_b32 v130, 1, v130
  v_or_b32 v129, v129, v130
  v_cmp_eq_u32 vcc, 0, v129
  v_mov_b32 v130, 0x80000000
  s_nop 0
  v_cndmask_b32 v145, v130, v131, vcc
  v_and_b32 v128, 15, v128
  v_xor_b32 v128, v128, v211
  v_lshl_add_u32 v145, v128, 4, v145
  s_add_u32 m0, s64, 0
  s_mov_b32 s70, 0
  buffer_load_dwordx4 v22, s[20:23], s70 offen lds
  s_addk_i32 m0, 1024
  s_addk_i32 s70, 4096
  buffer_load_dwordx4 v22, s[20:23], s70 offen lds
  s_addk_i32 m0, 1024
  s_addk_i32 s70, 4096
  buffer_load_dwordx4 v22, s[20:23], s70 offen lds
  s_addk_i32 m0, 1024
  s_addk_i32 s70, 4096
  buffer_load_dwordx4 v22, s[20:23], s70 offen lds
  s_addk_i32 m0, 1024
  s_addk_i32 s70, 4096
  buffer_load_dwordx4 v22, s[20:23], s70 offen lds
  s_addk_i32 m0, 1024
  s_addk_i32 s70, 4096
  buffer_load_dwordx4 v22, s[20:23], s70 offen lds
  s_addk_i32 m0, 1024
  s_addk_i32 s70, 4096
  buffer_load_dwordx4 v22, s[20:23], s70 offen lds
  s_addk_i32 m0, 1024
  s_addk_i32 s70, 4096
  buffer_load_dwordx4 v22, s[20:23], s70 offen lds
  s_mov_b32 s71, 0x4000
  v_cmp_le_u32 vcc, 10, v209
  v_subrev_u32 v129, 10, v209
  v_mov_b32 v130, -1
  v_mov_b32 v131, 16
  v_cndmask_b32 v129, v209, v129, vcc
  v_cndmask_b32 v130, v130, v131, vcc
  v_mul_u32_u24 v6, 0x1400, v129
  v_add_u32 v131, 1, v130
  v_mul_u32_u24 v131, 0x110, v131
  v_add3_u32 v6, v6, v131, s71
  v_mov_b32 v131, 0x19800
  v_cmp_gt_u32 vcc, 20, v209
  s_nop 1
  v_cndmask_b32 v6, v131, v6, vcc
  v_lshl_add_u32 v215, v210, 4, s60
  v_add_u32 v6, v6, v215
  v_lshrrev_b32 v129, 2, v211
  v_lshl_add_u32 v129, v210, 3, v129
  v_lshlrev_b32 v129, 6, v129
  v_and_b32 v130, 1, v0
  v_bfe_u32 v131, v0, 1, 1
  v_lshl_add_u32 v130, v130, 1, v131
  v_lshl_add_u32 v130, v212, 2, v130
  v_lshl_add_u32 v129, v130, 3, v129
  v_add_u32 v25, s64, v129
  v_xor_b32 v129, v210, v211
  v_lshlrev_b32 v129, 4, v129
  v_lshl_add_u32 v129, v209, 8, v129
  v_add_u32 v7, 0x8000, v129
  v_xor_b32 v8, 32, v7
  v_xor_b32 v9, 64, v7
  v_xor_b32 v10, 0x60, v7
  v_xor_b32 v11, 0x80, v7
  v_xor_b32 v12, 0xa0, v7
  v_xor_b32 v13, 0xc0, v7
  v_xor_b32 v14, 0xe0, v7
  v_xor_b32 v15, s60, v129
  v_xor_b32 v16, 32, v15
  v_add_u32 v17, 0x14000, v15
  v_add_u32 v18, 0x14000, v16
  s_lshl_b32 s74, s50, 12
  s_add_u32 s74, s74, 0x22400
  v_bfe_u32 v129, v0, 2, 2
  v_xor_b32 v129, v129, v210
  v_lshlrev_b32 v129, 4, v129
  v_lshl_add_u32 v129, v209, 6, v129
  v_add_u32 v20, s74, v129
  v_xor_b32 v21, 32, v20
  v_lshl_add_u32 v19, v208, 4, s74
  v_and_b32 v129, 3, v0
  v_xor_b32 v130, v129, v214
  v_lshl_add_u32 v130, v130, 4, s60
  v_lshl_add_u32 v2, v213, 8, v130
  v_mul_u32_u24 v129, 0x110, v211
  v_add_u32 v129, v129, v215
  v_add_u32 v129, 0x4110, v129
  v_mul_u32_u24 v130, 0x2800, v212
  v_add_u32 v3, v129, v130
  v_cmp_eq_u32 vcc, 0, v212
  v_mov_b32 v130, 0
  v_mov_b32 v131, 0x6400
  v_cndmask_b32 v130, v130, v131, vcc
  v_add_u32 v4, v129, v130
  v_mov_b32 v130, 0x8c00
  v_mov_b32 v131, 0xb400
  v_cndmask_b32 v130, v130, v131, vcc
  v_add_u32 v5, v129, v130
  v_mul_u32_u24 v129, 0x110, v211
  v_lshl_add_u32 v129, v210, 4, v129
  v_mul_u32_u24 v130, 0x2800, v212
  v_add_u32 v129, 0x4000, v129
  v_add_u32 v26, v129, v130
  v_mul_u32_u24 v129, 0x110, v209
  v_add_u32 v129, 0x19c00, v129
  v_add_u32 v27, v129, v215
  v_lshl_add_u32 v28, v210, 4, v129
  s_lshl_b32 s3, s50, 3
  v_lshlrev_b32 v129, 5, v209
  v_add_u32 v30, 0x18000, v129
  v_lshl_add_u32 v129, v210, 2, v30
  v_add_u32 v29, s3, v129
  v_add_u32 v23, 0x18000, v22
  v_add_u32 v24, 0x30000, v22
  s_mov_b32 s66, 0xbfb8aa3b
  s_mov_b32 s67, 0xbfb8aa3b
  s_mov_b32 s68, 0xffff0000
  s_mov_b32 s69, 0xffff0000
  s_mov_b32 s72, 0x3c000000
  s_mov_b32 s73, 0x3c000000
  s_mov_b32 s75, 0xffff0000
  s_add_u32 m0, s65, 0x10000
  s_nop 0
  buffer_load_dwordx4 v1, s[16:19], s45 offen nt lds
  s_addk_i32 m0, -16384
  s_nop 0
  buffer_load_dwordx4 v1, s[12:15], s45 offen nt lds
  s_addk_i32 m0, 20480
  s_nop 0
  buffer_load_dwordx4 v1, s[16:19], s40 offen nt lds
  s_addk_i32 m0, -16384
  s_nop 0
  buffer_load_dwordx4 v1, s[12:15], s40 offen nt lds
  s_addk_i32 m0, 20480
  s_nop 0
  buffer_load_dwordx4 v144, s[16:19], 0 offen nt lds
  s_addk_i32 m0, -16384
  s_nop 0
  buffer_load_dwordx4 v144, s[12:15], 0 offen nt lds
  s_addk_i32 m0, 20480
  s_nop 0
  buffer_load_dwordx4 v145, s[16:19], 0 offen nt lds
  s_addk_i32 m0, -16384
  s_nop 0
  buffer_load_dwordx4 v145, s[12:15], 0 offen nt lds
  s_waitcnt vmcnt(8)
  ds_read_b64_tr_b16 v[32:33], v25
  ds_read_b64_tr_b16 v[34:35], v25 offset:256
  ds_read_b64_tr_b16 v[36:37], v25 offset:1024
  ds_read_b64_tr_b16 v[38:39], v25 offset:1280
  ds_read_b64_tr_b16 v[40:41], v25 offset:2048
  ds_read_b64_tr_b16 v[42:43], v25 offset:2304
  ds_read_b64_tr_b16 v[44:45], v25 offset:3072
  ds_read_b64_tr_b16 v[46:47], v25 offset:3328
  ds_read_b64_tr_b16 v[48:49], v25 offset:4096
  ds_read_b64_tr_b16 v[50:51], v25 offset:4352
  ds_read_b64_tr_b16 v[52:53], v25 offset:5120
  ds_read_b64_tr_b16 v[54:55], v25 offset:5376
  ds_read_b64_tr_b16 v[56:57], v25 offset:6144
  ds_read_b64_tr_b16 v[58:59], v25 offset:6400
  ds_read_b64_tr_b16 v[60:61], v25 offset:7168
  ds_read_b64_tr_b16 v[62:63], v25 offset:7424
  s_barrier
  ds_read_b128 v[208:211], v15 offset:16384
  ds_read_b128 v[212:215], v16 offset:16384
  ds_read_b128 v[216:219], v7
  ds_read_b128 v[220:223], v8
  ds_read_b128 v[224:227], v9
  ds_read_b128 v[228:231], v10
  ds_read_b128 v[232:235], v11
  ds_read_b128 v[236:239], v12
  ds_read_b128 v[240:243], v13
  ds_read_b128 v[244:247], v14
  ds_read_b128 v[176:179], v15 offset:24576
  ds_read_b128 v[180:183], v16 offset:24576
  ds_read_b128 v[184:187], v7 offset:8192
  ds_read_b128 v[188:191], v8 offset:8192
  ds_read_b128 v[192:195], v9 offset:8192
  ds_read_b128 v[196:199], v10 offset:8192
  ds_read_b128 v[200:203], v11 offset:8192
  ds_read_b128 v[204:207], v12 offset:8192
  ds_read_b128 v[152:155], v13 offset:8192
  ds_read_b128 v[156:159], v14 offset:8192
  s_waitcnt lgkmcnt(15)
  v_lshlrev_b32 v64, 16, v208
  v_and_b32 v65, s75, v208
  v_lshlrev_b32 v66, 16, v209
  v_and_b32 v67, s75, v209
  v_lshlrev_b32 v68, 16, v210
  v_and_b32 v69, s75, v210
  v_lshlrev_b32 v70, 16, v211
  v_and_b32 v71, s75, v211
  v_lshlrev_b32 v72, 16, v212
  v_and_b32 v73, s75, v212
  v_lshlrev_b32 v74, 16, v213
  v_and_b32 v75, s75, v213
  v_lshlrev_b32 v76, 16, v214
  v_and_b32 v77, s75, v214
  v_lshlrev_b32 v78, 16, v215
  v_and_b32 v79, s75, v215
  s_nop 1
  v_mfma_f32_32x32x16_bf16 v[64:79], v[32:35], v[216:219], v[64:79]
  s_waitcnt lgkmcnt(9)
  v_lshlrev_b32 v80, 16, v176
  v_and_b32 v81, s75, v176
  v_lshlrev_b32 v82, 16, v177
  v_and_b32 v83, s75, v177
  v_lshlrev_b32 v84, 16, v178
  v_and_b32 v85, s75, v178
  v_mfma_f32_32x32x16_bf16 v[64:79], v[36:39], v[220:223], v[64:79]
  v_lshlrev_b32 v86, 16, v179
  v_and_b32 v87, s75, v179
  s_waitcnt lgkmcnt(8)
  v_lshlrev_b32 v88, 16, v180
  v_and_b32 v89, s75, v180
  v_lshlrev_b32 v90, 16, v181
  v_and_b32 v91, s75, v181
  v_mfma_f32_32x32x16_bf16 v[64:79], v[40:43], v[224:227], v[64:79]
  v_lshlrev_b32 v92, 16, v182
  v_and_b32 v93, s75, v182
  v_lshlrev_b32 v94, 16, v183
  v_and_b32 v95, s75, v183
  v_and_b32 v132, 63, v0
  v_min_u32 v132, 35, v132
  v_mfma_f32_32x32x16_bf16 v[64:79], v[44:47], v[228:231], v[64:79]
  v_lshlrev_b32 v132, 6, v132
  s_mul_i32 s3, s76, 0x900
  buffer_load_dword v130, v132, s[28:31], s3 offen
  v_and_b32 v133, 3, v0
  v_lshlrev_b32 v133, 6, v133
  v_mfma_f32_32x32x16_bf16 v[64:79], v[48:51], v[232:235], v[64:79]
  s_lshl_b32 s3, s76, 8
  v_mfma_f32_32x32x16_bf16 v[64:79], v[52:55], v[236:239], v[64:79]
  buffer_load_dword v131, v133, s[24:27], s3 offen
  s_add_u32 m0, s64, 0x2000
  s_addk_i32 s70, -28672
  v_mfma_f32_32x32x16_bf16 v[64:79], v[56:59], v[240:243], v[64:79]
  v_mfma_f32_32x32x16_bf16 v[64:79], v[60:63], v[244:247], v[64:79]
  buffer_load_dwordx4 v22, s[28:31], s70 offen lds
  s_addk_i32 m0, 1024
  s_waitcnt lgkmcnt(7)
  v_mfma_f32_32x32x16_bf16 v[80:95], v[32:35], v[184:187], v[80:95]
  s_waitcnt lgkmcnt(6)
  v_mfma_f32_32x32x16_bf16 v[80:95], v[36:39], v[188:191], v[80:95]
  s_nop 5
  v_add_f32 v160, v64, v65
  v_mul_f32 v161, v64, v64
  v_add_f32 v162, v66, v67
  v_mul_f32 v163, v65, v65
  v_fmac_f32 v161, v66, v66
  v_fmac_f32 v163, v67, v67
  s_waitcnt lgkmcnt(5)
  v_mfma_f32_32x32x16_bf16 v[80:95], v[40:43], v[192:195], v[80:95]
  v_fmac_f32 v161, v68, v68
  v_add_f32 v160, v68, v160
  v_fmac_f32 v163, v69, v69
  v_add_f32 v162, v69, v162
  v_fmac_f32 v161, v70, v70
  v_add_f32 v160, v70, v160
  s_waitcnt lgkmcnt(4)
  v_mfma_f32_32x32x16_bf16 v[80:95], v[44:47], v[196:199], v[80:95]
  v_fmac_f32 v163, v71, v71
  v_add_f32 v162, v71, v162
  v_fmac_f32 v161, v72, v72
  v_add_f32 v160, v72, v160
  v_fmac_f32 v163, v73, v73
  v_add_f32 v162, v73, v162
  s_waitcnt lgkmcnt(3)
  v_mfma_f32_32x32x16_bf16 v[80:95], v[48:51], v[200:203], v[80:95]
  v_fmac_f32 v161, v74, v74
  v_add_f32 v160, v74, v160
  v_fmac_f32 v163, v75, v75
  v_add_f32 v162, v75, v162
  v_fmac_f32 v161, v76, v76
  v_add_f32 v160, v76, v160
  s_waitcnt lgkmcnt(2)
  v_mfma_f32_32x32x16_bf16 v[80:95], v[52:55], v[204:207], v[80:95]
  v_fmac_f32 v163, v77, v77
  v_add_f32 v162, v77, v162
  v_fmac_f32 v161, v78, v78
  v_add_f32 v160, v78, v160
  v_fmac_f32 v163, v79, v79
  v_add_f32 v162, v79, v162
  s_waitcnt lgkmcnt(1)
  v_mfma_f32_32x32x16_bf16 v[80:95], v[56:59], v[152:155], v[80:95]
  v_add_f32 v160, v160, v162
  v_add_f32 v161, v161, v163
  s_nop 1
  v_permlane32_swap_b32 v160, v161
  v_add_f32 v160, v160, v161
  ds_write_b32 v29, v160
  s_waitcnt lgkmcnt(1)
  v_mfma_f32_32x32x16_bf16 v[80:95], v[60:63], v[156:159], v[80:95]
  buffer_load_dwordx4 v23, s[28:31], s70 offen lds
  s_addk_i32 m0, 1024
  s_nop 9
  v_pk_add_f32 v[162:163], v[80:81], v[82:83]
  v_pk_mul_f32 v[164:165], v[80:81], v[80:81]
  v_pk_fma_f32 v[164:165], v[82:83], v[82:83], v[164:165]
  v_pk_add_f32 v[162:163], v[162:163], v[84:85]
  v_pk_fma_f32 v[164:165], v[84:85], v[84:85], v[164:165]
  v_pk_add_f32 v[162:163], v[162:163], v[86:87]
  v_pk_fma_f32 v[164:165], v[86:87], v[86:87], v[164:165]
  v_pk_add_f32 v[162:163], v[162:163], v[88:89]
  v_pk_fma_f32 v[164:165], v[88:89], v[88:89], v[164:165]
  v_pk_add_f32 v[162:163], v[162:163], v[90:91]
  v_pk_fma_f32 v[164:165], v[90:91], v[90:91], v[164:165]
  v_pk_add_f32 v[162:163], v[162:163], v[92:93]
  v_pk_fma_f32 v[164:165], v[92:93], v[92:93], v[164:165]
  v_pk_add_f32 v[162:163], v[162:163], v[94:95]
  v_pk_fma_f32 v[164:165], v[94:95], v[94:95], v[164:165]
  v_add_f32 v160, v162, v163
  v_add_f32 v161, v164, v165
  s_nop 1
  v_permlane32_swap_b32 v160, v161
  v_add_f32 v160, v160, v161
  ds_write_b32 v29, v160 offset:1024
  s_waitcnt lgkmcnt(0)
  s_barrier
  ds_read_b128 v[176:179], v30
  ds_read_b128 v[180:183], v30 offset:16
  ds_read_b128 v[184:187], v30 offset:1024
  ds_read_b128 v[188:191], v30 offset:1040
  s_waitcnt lgkmcnt(3)
  v_pk_add_f32 v[176:177], v[176:177], v[178:179]
  s_waitcnt lgkmcnt(2)
  v_pk_add_f32 v[180:181], v[180:181], v[182:183]
  v_pk_add_f32 v[176:177], v[176:177], v[180:181]
  v_pk_mul_f32 v[176:177], v[176:177], s[72:73]
  buffer_load_dwordx4 v24, s[28:31], s70 offen lds
  v_fma_f32 v177, -v176, v176, v177
  v_max_f32 v177, 0, v177
  v_add_f32 v177, 0x3727c5ac, v177
  v_rsq_f32 v178, v177
  s_nop 0
  v_mul_f32 v178, 0xbfb8aa3b, v178
  v_mul_f32_e64 v179, -v176, v178
  v_pk_fma_f32 v[208:209], v[64:65], v[178:179], v[178:179] op_sel:[0,0,1] op_sel_hi:[1,0,1]
  v_pk_fma_f32 v[210:211], v[66:67], v[178:179], v[178:179] op_sel:[0,0,1] op_sel_hi:[1,0,1]
  s_addk_i32 m0, 1024
  s_addk_i32 s70, 4096
  buffer_load_dwordx4 v22, s[28:31], s70 offen lds
  v_pk_fma_f32 v[212:213], v[68:69], v[178:179], v[178:179] op_sel:[0,0,1] op_sel_hi:[1,0,1]
  v_pk_fma_f32 v[214:215], v[70:71], v[178:179], v[178:179] op_sel:[0,0,1] op_sel_hi:[1,0,1]
  v_exp_f32 v216, v208
  v_exp_f32 v217, v209
  v_exp_f32 v218, v210
  v_exp_f32 v219, v211
  v_exp_f32 v220, v212
  v_exp_f32 v221, v213
  s_addk_i32 m0, 1024
  s_nop 0
  buffer_load_dwordx4 v23, s[28:31], s70 offen lds
  v_exp_f32 v222, v214
  v_exp_f32 v223, v215
  v_pk_fma_f32 v[216:217], v[216:217], s[66:67], s[66:67]
  v_pk_fma_f32 v[218:219], v[218:219], s[66:67], s[66:67]
  v_pk_fma_f32 v[220:221], v[220:221], s[66:67], s[66:67]
  v_pk_fma_f32 v[222:223], v[222:223], s[66:67], s[66:67]
  v_rcp_f32 v216, v216
  v_rcp_f32 v217, v217
  s_addk_i32 m0, 1024
  s_nop 0
  buffer_load_dwordx4 v24, s[28:31], s70 offen lds
  v_rcp_f32 v218, v218
  v_rcp_f32 v219, v219
  v_rcp_f32 v220, v220
  v_rcp_f32 v221, v221
  v_rcp_f32 v222, v222
  v_rcp_f32 v223, v223
  v_pk_mul_f32 v[208:209], v[208:209], v[216:217]
  v_pk_mul_f32 v[210:211], v[210:211], v[218:219]
  s_addk_i32 m0, -13312
  s_addk_i32 s70, 4096
  buffer_load_dwordx4 v22, s[28:31], s70 offen lds
  v_pk_mul_f32 v[212:213], v[212:213], v[220:221]
  v_pk_mul_f32 v[214:215], v[214:215], v[222:223]
  v_cvt_pk_bf16_f32 v224, v208, v209
  v_cvt_pk_bf16_f32 v225, v210, v211
  v_cvt_pk_bf16_f32 v226, v212, v213
  v_cvt_pk_bf16_f32 v227, v214, v215
  v_pk_fma_f32 v[208:209], v[72:73], v[178:179], v[178:179] op_sel:[0,0,1] op_sel_hi:[1,0,1]
  v_pk_fma_f32 v[210:211], v[74:75], v[178:179], v[178:179] op_sel:[0,0,1] op_sel_hi:[1,0,1]
  s_addk_i32 m0, 1024
  s_nop 0
  buffer_load_dwordx4 v23, s[28:31], s70 offen lds
  v_pk_fma_f32 v[212:213], v[76:77], v[178:179], v[178:179] op_sel:[0,0,1] op_sel_hi:[1,0,1]
  v_pk_fma_f32 v[214:215], v[78:79], v[178:179], v[178:179] op_sel:[0,0,1] op_sel_hi:[1,0,1]
  v_exp_f32 v216, v208
  v_exp_f32 v217, v209
  v_exp_f32 v218, v210
  v_exp_f32 v219, v211
  v_exp_f32 v220, v212
  v_exp_f32 v221, v213
  s_addk_i32 m0, 1024
  s_nop 0
  buffer_load_dwordx4 v24, s[28:31], s70 offen lds
  v_exp_f32 v222, v214
  v_exp_f32 v223, v215
  v_pk_fma_f32 v[216:217], v[216:217], s[66:67], s[66:67]
  v_pk_fma_f32 v[218:219], v[218:219], s[66:67], s[66:67]
  v_pk_fma_f32 v[220:221], v[220:221], s[66:67], s[66:67]
  v_pk_fma_f32 v[222:223], v[222:223], s[66:67], s[66:67]
  v_rcp_f32 v216, v216
  v_rcp_f32 v217, v217
  s_addk_i32 m0, 1024
  s_addk_i32 s70, 4096
  buffer_load_dwordx4 v22, s[28:31], s70 offen lds
  v_rcp_f32 v218, v218
  v_rcp_f32 v219, v219
  v_rcp_f32 v220, v220
  v_rcp_f32 v221, v221
  v_rcp_f32 v222, v222
  v_rcp_f32 v223, v223
  v_pk_mul_f32 v[208:209], v[208:209], v[216:217]
  v_pk_mul_f32 v[210:211], v[210:211], v[218:219]
  s_addk_i32 m0, 1024
  s_nop 0
  buffer_load_dwordx4 v23, s[28:31], s70 offen lds
  v_pk_mul_f32 v[212:213], v[212:213], v[220:221]
  v_pk_mul_f32 v[214:215], v[214:215], v[222:223]
  v_cvt_pk_bf16_f32 v228, v208, v209
  v_cvt_pk_bf16_f32 v229, v210, v211
  v_cvt_pk_bf16_f32 v230, v212, v213
  v_cvt_pk_bf16_f32 v231, v214, v215
  ds_write_b128 v3, v[224:227] offset:5120
  ds_write_b128 v3, v[228:231] offset:5152
  s_addk_i32 m0, 1024
  s_nop 0
  buffer_load_dwordx4 v24, s[28:31], s70 offen lds
  s_waitcnt lgkmcnt(3)
  v_pk_add_f32 v[184:185], v[184:185], v[186:187]
  s_waitcnt lgkmcnt(2)
  v_pk_add_f32 v[188:189], v[188:189], v[190:191]
  v_pk_add_f32 v[184:185], v[184:185], v[188:189]
  v_pk_mul_f32 v[184:185], v[184:185], s[72:73]
  v_fma_f32 v185, -v184, v184, v185
  v_max_f32 v185, 0, v185
  v_add_f32 v185, 0x3727c5ac, v185
  v_rsq_f32 v186, v185
  s_addk_i32 m0, 1024
  s_addk_i32 s70, 4096
  buffer_load_dwordx4 v22, s[28:31], s70 offen lds
  v_mul_f32 v186, 0xbfb8aa3b, v186
  v_mul_f32_e64 v187, -v184, v186
  v_pk_fma_f32 v[208:209], v[80:81], v[186:187], v[186:187] op_sel:[0,0,1] op_sel_hi:[1,0,1]
  v_pk_fma_f32 v[210:211], v[82:83], v[186:187], v[186:187] op_sel:[0,0,1] op_sel_hi:[1,0,1]
  v_pk_fma_f32 v[212:213], v[84:85], v[186:187], v[186:187] op_sel:[0,0,1] op_sel_hi:[1,0,1]
  v_pk_fma_f32 v[214:215], v[86:87], v[186:187], v[186:187] op_sel:[0,0,1] op_sel_hi:[1,0,1]
  v_exp_f32 v216, v208
  v_exp_f32 v217, v209
  s_addk_i32 m0, 1024
  s_nop 0
  buffer_load_dwordx4 v23, s[28:31], s70 offen lds
  v_exp_f32 v218, v210
  v_exp_f32 v219, v211
  v_exp_f32 v220, v212
  v_exp_f32 v221, v213
  v_exp_f32 v222, v214
  v_exp_f32 v223, v215
  v_pk_fma_f32 v[216:217], v[216:217], s[66:67], s[66:67]
  v_pk_fma_f32 v[218:219], v[218:219], s[66:67], s[66:67]
  s_add_u32 m0, s65, 0x14000
  s_nop 0
  buffer_load_dwordx4 v1, s[16:19], s46 offen nt lds
  v_pk_fma_f32 v[220:221], v[220:221], s[66:67], s[66:67]
  v_pk_fma_f32 v[222:223], v[222:223], s[66:67], s[66:67]
  v_rcp_f32 v216, v216
  v_rcp_f32 v217, v217
  v_rcp_f32 v218, v218
  v_rcp_f32 v219, v219
  v_rcp_f32 v220, v220
  v_rcp_f32 v221, v221
  s_add_u32 m0, s65, 0
  s_nop 0
  buffer_load_dwordx4 v1, s[12:15], s46 offen nt lds
  v_rcp_f32 v222, v222
  v_rcp_f32 v223, v223
  v_pk_mul_f32 v[208:209], v[208:209], v[216:217]
  v_pk_mul_f32 v[210:211], v[210:211], v[218:219]
  v_pk_mul_f32 v[212:213], v[212:213], v[220:221]
  v_pk_mul_f32 v[214:215], v[214:215], v[222:223]
  v_cvt_pk_bf16_f32 v224, v208, v209
  v_cvt_pk_bf16_f32 v225, v210, v211
  s_add_u32 m0, s65, 0x15000
  s_nop 0
  buffer_load_dwordx4 v1, s[16:19], s48 offen nt lds
  v_cvt_pk_bf16_f32 v226, v212, v213
  v_cvt_pk_bf16_f32 v227, v214, v215
  v_pk_fma_f32 v[208:209], v[88:89], v[186:187], v[186:187] op_sel:[0,0,1] op_sel_hi:[1,0,1]
  v_pk_fma_f32 v[210:211], v[90:91], v[186:187], v[186:187] op_sel:[0,0,1] op_sel_hi:[1,0,1]
  v_pk_fma_f32 v[212:213], v[92:93], v[186:187], v[186:187] op_sel:[0,0,1] op_sel_hi:[1,0,1]
  v_pk_fma_f32 v[214:215], v[94:95], v[186:187], v[186:187] op_sel:[0,0,1] op_sel_hi:[1,0,1]
  v_exp_f32 v216, v208
  v_exp_f32 v217, v209
  s_add_u32 m0, s65, 0x1000
  s_nop 0
  buffer_load_dwordx4 v1, s[12:15], s48 offen nt lds
  v_exp_f32 v218, v210
  v_exp_f32 v219, v211
  v_exp_f32 v220, v212
  v_exp_f32 v221, v213
  v_exp_f32 v222, v214
  v_exp_f32 v223, v215
  v_pk_fma_f32 v[216:217], v[216:217], s[66:67], s[66:67]
  v_pk_fma_f32 v[218:219], v[218:219], s[66:67], s[66:67]
  s_add_u32 m0, s65, 0x16000
  s_nop 0
  buffer_load_dwordx4 v1, s[16:19], s49 offen nt lds
  v_pk_fma_f32 v[220:221], v[220:221], s[66:67], s[66:67]
  v_pk_fma_f32 v[222:223], v[222:223], s[66:67], s[66:67]
  v_rcp_f32 v216, v216
  v_rcp_f32 v217, v217
  v_rcp_f32 v218, v218
  v_rcp_f32 v219, v219
  v_rcp_f32 v220, v220
  v_rcp_f32 v221, v221
  s_add_u32 m0, s65, 0x2000
  s_nop 0
  buffer_load_dwordx4 v1, s[12:15], s49 offen nt lds
  v_rcp_f32 v222, v222
  v_rcp_f32 v223, v223
  v_pk_mul_f32 v[208:209], v[208:209], v[216:217]
  v_pk_mul_f32 v[210:211], v[210:211], v[218:219]
  v_pk_mul_f32 v[212:213], v[212:213], v[220:221]
  v_pk_mul_f32 v[214:215], v[214:215], v[222:223]
  v_cvt_pk_bf16_f32 v228, v208, v209
  v_cvt_pk_bf16_f32 v229, v210, v211
  s_add_u32 m0, s65, 0x17000
  s_nop 0
  buffer_load_dwordx4 v1, s[16:19], s47 offen nt lds
  v_cvt_pk_bf16_f32 v230, v212, v213
  v_cvt_pk_bf16_f32 v231, v214, v215
  ds_write_b128 v3, v[224:227] offset:10240
  ds_write_b128 v3, v[228:231] offset:10272
  s_add_u32 m0, s65, 0x3000
  s_nop 0
  buffer_load_dwordx4 v1, s[12:15], s47 offen nt lds
  s_waitcnt vmcnt(24)
  s_barrier
  ds_read_b128 v[208:211], v15 offset:49152
  ds_read_b128 v[212:215], v16 offset:49152
  ds_read_b128 v[216:219], v7 offset:32768
  ds_read_b128 v[220:223], v8 offset:32768
  ds_read_b128 v[224:227], v9 offset:32768
  ds_read_b128 v[228:231], v10 offset:32768
  ds_read_b128 v[232:235], v11 offset:32768
  ds_read_b128 v[236:239], v12 offset:32768
  ds_read_b128 v[240:243], v13 offset:32768
  ds_read_b128 v[244:247], v14 offset:32768
  ds_read_b128 v[176:179], v15 offset:57344
  ds_read_b128 v[180:183], v16 offset:57344
  ds_read_b128 v[184:187], v7 offset:40960
  ds_read_b128 v[188:191], v8 offset:40960
  ds_read_b128 v[192:195], v9 offset:40960
  ds_read_b128 v[196:199], v10 offset:40960
  ds_read_b128 v[200:203], v11 offset:40960
  ds_read_b128 v[204:207], v12 offset:40960
  ds_read_b128 v[152:155], v13 offset:40960
  ds_read_b128 v[156:159], v14 offset:40960
  s_waitcnt lgkmcnt(15)
  v_lshlrev_b32 v96, 16, v208
  v_and_b32 v97, s75, v208
  v_lshlrev_b32 v98, 16, v209
  v_and_b32 v99, s75, v209
  v_lshlrev_b32 v100, 16, v210
  v_and_b32 v101, s75, v210
  v_lshlrev_b32 v102, 16, v211
  v_and_b32 v103, s75, v211
  v_lshlrev_b32 v104, 16, v212
  v_and_b32 v105, s75, v212
  v_lshlrev_b32 v106, 16, v213
  v_and_b32 v107, s75, v213
  v_lshlrev_b32 v108, 16, v214
  v_and_b32 v109, s75, v214
  v_lshlrev_b32 v110, 16, v215
  v_and_b32 v111, s75, v215
  s_nop 1
  v_mfma_f32_32x32x16_bf16 v[96:111], v[32:35], v[216:219], v[96:111]
  s_waitcnt lgkmcnt(9)
  v_lshlrev_b32 v112, 16, v176
  v_and_b32 v113, s75, v176
  v_lshlrev_b32 v114, 16, v177
  v_and_b32 v115, s75, v177
  v_lshlrev_b32 v116, 16, v178
  v_and_b32 v117, s75, v178
  v_mfma_f32_32x32x16_bf16 v[96:111], v[36:39], v[220:223], v[96:111]
  v_lshlrev_b32 v118, 16, v179
  v_and_b32 v119, s75, v179
  s_waitcnt lgkmcnt(8)
  v_lshlrev_b32 v120, 16, v180
  v_and_b32 v121, s75, v180
  v_lshlrev_b32 v122, 16, v181
  v_and_b32 v123, s75, v181
  v_mfma_f32_32x32x16_bf16 v[96:111], v[40:43], v[224:227], v[96:111]
  v_lshlrev_b32 v124, 16, v182
  v_and_b32 v125, s75, v182
  v_lshlrev_b32 v126, 16, v183
  v_and_b32 v127, s75, v183
  s_waitcnt vmcnt(8)
  ds_read_b64_tr_b16 a[0:1], v25 offset:8192
  v_mfma_f32_32x32x16_bf16 v[96:111], v[44:47], v[228:231], v[96:111]
  ds_read_b64_tr_b16 a[2:3], v25 offset:8448
  ds_read_b64_tr_b16 a[4:5], v25 offset:9216
  ds_read_b64_tr_b16 a[6:7], v25 offset:9472
  ds_read_b64_tr_b16 a[8:9], v25 offset:10240
  v_mfma_f32_32x32x16_bf16 v[96:111], v[48:51], v[232:235], v[96:111]
  ds_read_b64_tr_b16 a[10:11], v25 offset:10496
  ds_read_b64_tr_b16 a[12:13], v25 offset:11264
  ds_read_b64_tr_b16 a[14:15], v25 offset:11520
  ds_read_b64_tr_b16 a[16:17], v25 offset:12288
  v_mfma_f32_32x32x16_bf16 v[96:111], v[52:55], v[236:239], v[96:111]
  ds_read_b64_tr_b16 a[18:19], v25 offset:12544
  ds_read_b64_tr_b16 a[20:21], v25 offset:13312
  ds_read_b64_tr_b16 a[22:23], v25 offset:13568
  ds_read_b64_tr_b16 a[24:25], v25
  v_mfma_f32_32x32x16_bf16 v[96:111], v[56:59], v[240:243], v[96:111]
  ds_read_b64_tr_b16 a[26:27], v25 offset:256
  ds_read_b64_tr_b16 a[28:29], v25 offset:1024
  ds_read_b64_tr_b16 a[30:31], v25 offset:1280
  ds_read_b64_tr_b16 a[32:33], v25 offset:2048
  v_mfma_f32_32x32x16_bf16 v[96:111], v[60:63], v[244:247], v[96:111]
  ds_read_b64_tr_b16 a[34:35], v25 offset:2304
  ds_read_b64_tr_b16 a[36:37], v25 offset:3072
  ds_read_b64_tr_b16 a[38:39], v25 offset:3328
  ds_read_b64_tr_b16 a[40:41], v25 offset:4096
  s_waitcnt lgkmcnt(15)
  v_mfma_f32_32x32x16_bf16 v[112:127], v[32:35], v[184:187], v[112:127]
  ds_read_b64_tr_b16 a[42:43], v25 offset:4352
  ds_read_b64_tr_b16 a[44:45], v25 offset:5120
  ds_read_b64_tr_b16 a[46:47], v25 offset:5376
  ds_read_b64_tr_b16 a[48:49], v25 offset:6144
  v_mfma_f32_32x32x16_bf16 v[112:127], v[36:39], v[188:191], v[112:127]
  s_nop 0
  v_add_f32 v160, v96, v97
  v_mul_f32 v161, v96, v96
  v_add_f32 v162, v98, v99
  v_mul_f32 v163, v97, v97
  v_fmac_f32 v161, v98, v98
  v_fmac_f32 v163, v99, v99
  v_mfma_f32_32x32x16_bf16 v[112:127], v[40:43], v[192:195], v[112:127]
  v_fmac_f32 v161, v100, v100
  v_add_f32 v160, v100, v160
  v_fmac_f32 v163, v101, v101
  v_add_f32 v162, v101, v162
  v_fmac_f32 v161, v102, v102
  v_add_f32 v160, v102, v160
  v_mfma_f32_32x32x16_bf16 v[112:127], v[44:47], v[196:199], v[112:127]
  v_fmac_f32 v163, v103, v103
  v_add_f32 v162, v103, v162
  v_fmac_f32 v161, v104, v104
  v_add_f32 v160, v104, v160
  v_fmac_f32 v163, v105, v105
  v_add_f32 v162, v105, v162
  v_mfma_f32_32x32x16_bf16 v[112:127], v[48:51], v[200:203], v[112:127]
  v_fmac_f32 v161, v106, v106
  v_add_f32 v160, v106, v160
  v_fmac_f32 v163, v107, v107
  v_add_f32 v162, v107, v162
  v_fmac_f32 v161, v108, v108
  v_add_f32 v160, v108, v160
  v_mfma_f32_32x32x16_bf16 v[112:127], v[52:55], v[204:207], v[112:127]
  v_fmac_f32 v163, v109, v109
  v_add_f32 v162, v109, v162
  v_fmac_f32 v161, v110, v110
  v_add_f32 v160, v110, v160
  v_fmac_f32 v163, v111, v111
  v_add_f32 v162, v111, v162
  v_mfma_f32_32x32x16_bf16 v[112:127], v[56:59], v[152:155], v[112:127]
  v_add_f32 v160, v160, v162
  v_add_f32 v161, v161, v163
  s_nop 1
  v_permlane32_swap_b32 v160, v161
  v_add_f32 v160, v160, v161
  ds_write_b32 v29, v160 offset:2048
  v_mfma_f32_32x32x16_bf16 v[112:127], v[60:63], v[156:159], v[112:127]
  ds_read_b64_tr_b16 a[50:51], v25 offset:6400
  ds_read_b64_tr_b16 a[52:53], v25 offset:7168
  ds_read_b64_tr_b16 a[54:55], v25 offset:7424
  s_waitcnt lgkmcnt(0)
  s_add_u32 m0, s64, 0x2000
  s_nop 6
  v_pk_add_f32 v[162:163], v[112:113], v[114:115]
  v_pk_mul_f32 v[164:165], v[112:113], v[112:113]
  v_pk_fma_f32 v[164:165], v[114:115], v[114:115], v[164:165]
  v_pk_add_f32 v[162:163], v[162:163], v[116:117]
  v_pk_fma_f32 v[164:165], v[116:117], v[116:117], v[164:165]
  v_pk_add_f32 v[162:163], v[162:163], v[118:119]
  v_pk_fma_f32 v[164:165], v[118:119], v[118:119], v[164:165]
  v_pk_add_f32 v[162:163], v[162:163], v[120:121]
  v_pk_fma_f32 v[164:165], v[120:121], v[120:121], v[164:165]
  v_pk_add_f32 v[162:163], v[162:163], v[122:123]
  v_pk_fma_f32 v[164:165], v[122:123], v[122:123], v[164:165]
  v_pk_add_f32 v[162:163], v[162:163], v[124:125]
  v_pk_fma_f32 v[164:165], v[124:125], v[124:125], v[164:165]
  v_pk_add_f32 v[162:163], v[162:163], v[126:127]
  v_pk_fma_f32 v[164:165], v[126:127], v[126:127], v[164:165]
  v_add_f32 v160, v162, v163
  v_add_f32 v161, v164, v165
  s_nop 1
  v_permlane32_swap_b32 v160, v161
  v_add_f32 v160, v160, v161
  ds_write_b32 v29, v160 offset:3072
  s_waitcnt lgkmcnt(0)
  s_barrier
  ds_read_b128 v[176:179], v30 offset:2048
  ds_read_b128 v[180:183], v30 offset:2064
  ds_read_b128 v[184:187], v30 offset:3072
  ds_read_b128 v[188:191], v30 offset:3088
  s_waitcnt lgkmcnt(3)
  v_pk_add_f32 v[176:177], v[176:177], v[178:179]
  s_waitcnt lgkmcnt(2)
  v_pk_add_f32 v[180:181], v[180:181], v[182:183]
  v_pk_add_f32 v[176:177], v[176:177], v[180:181]
  v_pk_mul_f32 v[176:177], v[176:177], s[72:73]
  buffer_load_dwordx4 v24, s[28:31], s70 offen lds
  v_fma_f32 v177, -v176, v176, v177
  v_max_f32 v177, 0, v177
  v_add_f32 v177, 0x3727c5ac, v177
  v_rsq_f32 v178, v177
  s_nop 0
  v_mul_f32 v178, 0xbfb8aa3b, v178
  v_mul_f32_e64 v179, -v176, v178
  v_pk_fma_f32 v[208:209], v[96:97], v[178:179], v[178:179] op_sel:[0,0,1] op_sel_hi:[1,0,1]
  v_pk_fma_f32 v[210:211], v[98:99], v[178:179], v[178:179] op_sel:[0,0,1] op_sel_hi:[1,0,1]
  s_addk_i32 m0, 1024
  s_addk_i32 s70, 4096
  buffer_load_dwordx4 v22, s[28:31], s70 offen lds
  v_pk_fma_f32 v[212:213], v[100:101], v[178:179], v[178:179] op_sel:[0,0,1] op_sel_hi:[1,0,1]
  v_pk_fma_f32 v[214:215], v[102:103], v[178:179], v[178:179] op_sel:[0,0,1] op_sel_hi:[1,0,1]
  v_exp_f32 v216, v208
  v_exp_f32 v217, v209
  v_exp_f32 v218, v210
  v_exp_f32 v219, v211
  v_exp_f32 v220, v212
  v_exp_f32 v221, v213
  s_addk_i32 m0, 1024
  s_nop 0
  buffer_load_dwordx4 v23, s[28:31], s70 offen lds
  v_exp_f32 v222, v214
  v_exp_f32 v223, v215
  v_pk_fma_f32 v[216:217], v[216:217], s[66:67], s[66:67]
  v_pk_fma_f32 v[218:219], v[218:219], s[66:67], s[66:67]
  v_pk_fma_f32 v[220:221], v[220:221], s[66:67], s[66:67]
  v_pk_fma_f32 v[222:223], v[222:223], s[66:67], s[66:67]
  v_rcp_f32 v216, v216
  v_rcp_f32 v217, v217
  s_addk_i32 m0, 1024
  s_nop 0
  buffer_load_dwordx4 v24, s[28:31], s70 offen lds
  v_rcp_f32 v218, v218
  v_rcp_f32 v219, v219
  v_rcp_f32 v220, v220
  v_rcp_f32 v221, v221
  v_rcp_f32 v222, v222
  v_rcp_f32 v223, v223
  v_pk_mul_f32 v[208:209], v[208:209], v[216:217]
  v_pk_mul_f32 v[210:211], v[210:211], v[218:219]
  s_addk_i32 m0, 1024
  s_addk_i32 s70, 4096
  buffer_load_dwordx4 v22, s[28:31], s70 offen lds
  v_pk_mul_f32 v[212:213], v[212:213], v[220:221]
  v_pk_mul_f32 v[214:215], v[214:215], v[222:223]
  v_cvt_pk_bf16_f32 v224, v208, v209
  v_cvt_pk_bf16_f32 v225, v210, v211
  v_cvt_pk_bf16_f32 v226, v212, v213
  v_cvt_pk_bf16_f32 v227, v214, v215
  v_pk_fma_f32 v[208:209], v[104:105], v[178:179], v[178:179] op_sel:[0,0,1] op_sel_hi:[1,0,1]
  v_pk_fma_f32 v[210:211], v[106:107], v[178:179], v[178:179] op_sel:[0,0,1] op_sel_hi:[1,0,1]
  s_addk_i32 m0, 1024
  s_nop 0
  buffer_load_dwordx4 v23, s[28:31], s70 offen lds
  v_pk_fma_f32 v[212:213], v[108:109], v[178:179], v[178:179] op_sel:[0,0,1] op_sel_hi:[1,0,1]
  v_pk_fma_f32 v[214:215], v[110:111], v[178:179], v[178:179] op_sel:[0,0,1] op_sel_hi:[1,0,1]
  v_exp_f32 v216, v208
  v_exp_f32 v217, v209
  v_exp_f32 v218, v210
  v_exp_f32 v219, v211
  v_exp_f32 v220, v212
  v_exp_f32 v221, v213
  s_addk_i32 m0, -13312
  s_nop 0
  buffer_load_dwordx4 v24, s[28:31], s70 offen lds
  v_exp_f32 v222, v214
  v_exp_f32 v223, v215
  v_pk_fma_f32 v[216:217], v[216:217], s[66:67], s[66:67]
  v_pk_fma_f32 v[218:219], v[218:219], s[66:67], s[66:67]
  v_pk_fma_f32 v[220:221], v[220:221], s[66:67], s[66:67]
  v_pk_fma_f32 v[222:223], v[222:223], s[66:67], s[66:67]
  v_rcp_f32 v216, v216
  v_rcp_f32 v217, v217
  s_addk_i32 m0, 1024
  s_addk_i32 s70, 4096
  buffer_load_dwordx4 v22, s[28:31], s70 offen lds
  v_rcp_f32 v218, v218
  v_rcp_f32 v219, v219
  v_rcp_f32 v220, v220
  v_rcp_f32 v221, v221
  v_rcp_f32 v222, v222
  v_rcp_f32 v223, v223
  v_pk_mul_f32 v[208:209], v[208:209], v[216:217]
  v_pk_mul_f32 v[210:211], v[210:211], v[218:219]
  s_addk_i32 m0, 1024
  s_nop 0
  buffer_load_dwordx4 v23, s[28:31], s70 offen lds
  v_pk_mul_f32 v[212:213], v[212:213], v[220:221]
  v_pk_mul_f32 v[214:215], v[214:215], v[222:223]
  v_cvt_pk_bf16_f32 v228, v208, v209
  v_cvt_pk_bf16_f32 v229, v210, v211
  v_cvt_pk_bf16_f32 v230, v212, v213
  v_cvt_pk_bf16_f32 v231, v214, v215
  ds_write_b128 v4, v[224:227]
  ds_write_b128 v4, v[228:231] offset:32
  s_addk_i32 m0, 1024
  s_nop 0
  buffer_load_dwordx4 v24, s[28:31], s70 offen lds
  s_waitcnt lgkmcnt(3)
  v_pk_add_f32 v[184:185], v[184:185], v[186:187]
  s_waitcnt lgkmcnt(2)
  v_pk_add_f32 v[188:189], v[188:189], v[190:191]
  v_pk_add_f32 v[184:185], v[184:185], v[188:189]
  v_pk_mul_f32 v[184:185], v[184:185], s[72:73]
  v_fma_f32 v185, -v184, v184, v185
  v_max_f32 v185, 0, v185
  v_add_f32 v185, 0x3727c5ac, v185
  v_rsq_f32 v186, v185
  s_addk_i32 m0, 1024
  s_addk_i32 s70, 4096
  buffer_load_dwordx4 v22, s[28:31], s70 offen lds
  v_mul_f32 v186, 0xbfb8aa3b, v186
  v_mul_f32_e64 v187, -v184, v186
  v_pk_fma_f32 v[208:209], v[112:113], v[186:187], v[186:187] op_sel:[0,0,1] op_sel_hi:[1,0,1]
  v_pk_fma_f32 v[210:211], v[114:115], v[186:187], v[186:187] op_sel:[0,0,1] op_sel_hi:[1,0,1]
  v_pk_fma_f32 v[212:213], v[116:117], v[186:187], v[186:187] op_sel:[0,0,1] op_sel_hi:[1,0,1]
  v_pk_fma_f32 v[214:215], v[118:119], v[186:187], v[186:187] op_sel:[0,0,1] op_sel_hi:[1,0,1]
  v_exp_f32 v216, v208
  v_exp_f32 v217, v209
  s_addk_i32 m0, 1024
  s_nop 0
  buffer_load_dwordx4 v23, s[28:31], s70 offen lds
  v_exp_f32 v218, v210
  v_exp_f32 v219, v211
  v_exp_f32 v220, v212
  v_exp_f32 v221, v213
  v_exp_f32 v222, v214
  v_exp_f32 v223, v215
  v_pk_fma_f32 v[216:217], v[216:217], s[66:67], s[66:67]
  v_pk_fma_f32 v[218:219], v[218:219], s[66:67], s[66:67]
  s_addk_i32 m0, 1024
  s_nop 0
  buffer_load_dwordx4 v24, s[28:31], s70 offen lds
  v_pk_fma_f32 v[220:221], v[220:221], s[66:67], s[66:67]
  v_pk_fma_f32 v[222:223], v[222:223], s[66:67], s[66:67]
  v_rcp_f32 v216, v216
  v_rcp_f32 v217, v217
  v_rcp_f32 v218, v218
  v_rcp_f32 v219, v219
  v_rcp_f32 v220, v220
  v_rcp_f32 v221, v221
  s_addk_i32 m0, 1024
  s_addk_i32 s70, 4096
  buffer_load_dwordx4 v22, s[28:31], s70 offen lds
  v_rcp_f32 v222, v222
  v_rcp_f32 v223, v223
  v_pk_mul_f32 v[208:209], v[208:209], v[216:217]
  v_pk_mul_f32 v[210:211], v[210:211], v[218:219]
  v_pk_mul_f32 v[212:213], v[212:213], v[220:221]
  v_pk_mul_f32 v[214:215], v[214:215], v[222:223]
  v_cvt_pk_bf16_f32 v224, v208, v209
  v_cvt_pk_bf16_f32 v225, v210, v211
  v_cvt_pk_bf16_f32 v226, v212, v213
  v_cvt_pk_bf16_f32 v227, v214, v215
  v_pk_fma_f32 v[208:209], v[120:121], v[186:187], v[186:187] op_sel:[0,0,1] op_sel_hi:[1,0,1]
  v_pk_fma_f32 v[210:211], v[122:123], v[186:187], v[186:187] op_sel:[0,0,1] op_sel_hi:[1,0,1]
  v_pk_fma_f32 v[212:213], v[124:125], v[186:187], v[186:187] op_sel:[0,0,1] op_sel_hi:[1,0,1]
  v_pk_fma_f32 v[214:215], v[126:127], v[186:187], v[186:187] op_sel:[0,0,1] op_sel_hi:[1,0,1]
  v_exp_f32 v216, v208
  v_exp_f32 v217, v209
  v_exp_f32 v218, v210
  v_exp_f32 v219, v211
  v_exp_f32 v220, v212
  v_exp_f32 v221, v213
  v_exp_f32 v222, v214
  v_exp_f32 v223, v215
  v_pk_fma_f32 v[216:217], v[216:217], s[66:67], s[66:67]
  v_pk_fma_f32 v[218:219], v[218:219], s[66:67], s[66:67]
  v_pk_fma_f32 v[220:221], v[220:221], s[66:67], s[66:67]
  v_pk_fma_f32 v[222:223], v[222:223], s[66:67], s[66:67]
  v_rcp_f32 v216, v216
  v_rcp_f32 v217, v217
  v_rcp_f32 v218, v218
  v_rcp_f32 v219, v219
  v_rcp_f32 v220, v220
  v_rcp_f32 v221, v221
  v_rcp_f32 v222, v222
  v_rcp_f32 v223, v223
  v_pk_mul_f32 v[208:209], v[208:209], v[216:217]
  v_pk_mul_f32 v[210:211], v[210:211], v[218:219]
  v_pk_mul_f32 v[212:213], v[212:213], v[220:221]
  v_pk_mul_f32 v[214:215], v[214:215], v[222:223]
  v_cvt_pk_bf16_f32 v228, v208, v209
  v_cvt_pk_bf16_f32 v229, v210, v211
  v_cvt_pk_bf16_f32 v230, v212, v213
  v_cvt_pk_bf16_f32 v231, v214, v215
  ds_write_b128 v6, v[224:227]
  ds_write_b128 v6, v[228:231] offset:32
  s_waitcnt vmcnt(0)
  ds_read_b64_tr_b16 a[56:57], v25 offset:8192
  ds_read_b64_tr_b16 a[58:59], v25 offset:8448
  ds_read_b64_tr_b16 a[60:61], v25 offset:9216
  ds_read_b64_tr_b16 a[62:63], v25 offset:9472
  ds_read_b64_tr_b16 a[64:65], v25 offset:10240
  ds_read_b64_tr_b16 a[66:67], v25 offset:10496
  ds_read_b64_tr_b16 a[68:69], v25 offset:11264
  ds_read_b64_tr_b16 a[70:71], v25 offset:11520
  ds_read_b64_tr_b16 a[72:73], v25 offset:12288
  ds_read_b64_tr_b16 a[74:75], v25 offset:12544
  ds_read_b64_tr_b16 a[76:77], v25 offset:13312
  ds_read_b64_tr_b16 a[78:79], v25 offset:13568
  ds_read_b64_tr_b16 a[80:81], v25
  ds_read_b64_tr_b16 a[82:83], v25 offset:256
  ds_read_b64_tr_b16 a[84:85], v25 offset:1024
  ds_read_b64_tr_b16 a[86:87], v25 offset:1280
  ds_read_b64_tr_b16 a[88:89], v25 offset:2048
  ds_read_b64_tr_b16 a[90:91], v25 offset:2304
  ds_read_b64_tr_b16 a[92:93], v25 offset:3072
  ds_read_b64_tr_b16 a[94:95], v25 offset:3328
  ds_read_b64_tr_b16 a[96:97], v25 offset:4096
  ds_read_b64_tr_b16 a[98:99], v25 offset:4352
  ds_read_b64_tr_b16 a[100:101], v25 offset:5120
  ds_read_b64_tr_b16 a[102:103], v25 offset:5376
  ds_read_b64_tr_b16 a[104:105], v25 offset:6144
  ds_read_b64_tr_b16 a[106:107], v25 offset:6400
  ds_read_b64_tr_b16 a[108:109], v25 offset:7168
  ds_read_b64_tr_b16 a[110:111], v25 offset:7424
  s_waitcnt lgkmcnt(15)
  s_barrier
  ds_read_b128 v[176:179], v26
  ds_read_b128 v[180:183], v26 offset:5120
  ds_read_b128 v[184:187], v26 offset:10240
  ds_read_b128 v[188:191], v26 offset:15360
  s_waitcnt lgkmcnt(3)
  v_mfma_f32_32x32x16_bf16 v[64:79], a[0:3], v[176:179], v[64:79]
  ds_read_b128 v[192:195], v26 offset:32
  ds_read_b128 v[196:199], v26 offset:5152
  s_waitcnt lgkmcnt(4)
  v_mfma_f32_32x32x16_bf16 v[80:95], a[0:3], v[180:183], v[80:95]
  ds_read_b128 v[200:203], v26 offset:10272
  ds_read_b128 v[204:207], v26 offset:15392
  s_addk_i32 m0, 1024
  s_nop 0
  buffer_load_dwordx4 v23, s[28:31], s70 offen lds
  v_mfma_f32_32x32x16_bf16 v[64:79], a[4:7], v[180:183], v[64:79]
  s_addk_i32 m0, 1024
  s_waitcnt lgkmcnt(5)
  v_mfma_f32_32x32x16_bf16 v[80:95], a[4:7], v[184:187], v[80:95]
  buffer_load_dwordx4 v24, s[28:31], s70 offen lds
  s_addk_i32 m0, 1024
  s_addk_i32 s70, 4096
  v_mfma_f32_32x32x16_bf16 v[64:79], a[8:11], v[184:187], v[64:79]
  s_waitcnt lgkmcnt(4)
  v_mfma_f32_32x32x16_bf16 v[80:95], a[8:11], v[188:191], v[80:95]
  buffer_load_dwordx4 v22, s[28:31], s70 offen lds
  s_waitcnt lgkmcnt(0)
  v_mfma_f32_32x32x16_bf16 v[64:79], a[12:15], v[192:195], v[64:79]
  ds_read_b128 v[176:179], v26 offset:64
  ds_read_b128 v[180:183], v26 offset:5184
  v_mfma_f32_32x32x16_bf16 v[80:95], a[12:15], v[196:199], v[80:95]
  ds_read_b128 v[184:187], v26 offset:10304
  ds_read_b128 v[188:191], v26 offset:15424
  s_addk_i32 m0, 1024
  s_nop 0
  buffer_load_dwordx4 v23, s[28:31], s70 offen lds
  s_addk_i32 m0, 1024
  v_mfma_f32_32x32x16_bf16 v[64:79], a[16:19], v[196:199], v[64:79]
  v_mfma_f32_32x32x16_bf16 v[80:95], a[16:19], v[200:203], v[80:95]
  buffer_load_dwordx4 v24, s[28:31], s70 offen lds
  s_addk_i32 m0, 1024
  s_addk_i32 s70, 4096
  v_mfma_f32_32x32x16_bf16 v[64:79], a[20:23], v[200:203], v[64:79]
  s_barrier
  ds_read_b128 v[240:243], v15
  ds_read_b128 v[244:247], v16
  v_mfma_f32_32x32x16_bf16 v[80:95], a[20:23], v[204:207], v[80:95]
  buffer_load_dwordx4 v22, s[28:31], s70 offen lds
  ds_read_b128 v[208:211], v7 offset:49152
  ds_read_b128 v[212:215], v8 offset:49152
  s_waitcnt lgkmcnt(4)
  v_mfma_f32_32x32x16_bf16 v[64:79], a[24:27], v[176:179], v[64:79]
  ds_read_b128 v[192:195], v26 offset:96
  ds_read_b128 v[196:199], v26 offset:5216
  v_mfma_f32_32x32x16_bf16 v[80:95], a[24:27], v[180:183], v[80:95]
  ds_read_b128 v[200:203], v26 offset:10336
  ds_read_b128 v[204:207], v26 offset:15456
  s_addk_i32 m0, -13312
  s_nop 0
  buffer_load_dwordx4 v23, s[28:31], s70 offen lds
  s_addk_i32 m0, 1024
  v_mfma_f32_32x32x16_bf16 v[64:79], a[28:31], v[180:183], v[64:79]
  ds_read_b128 v[216:219], v9 offset:49152
  ds_read_b128 v[220:223], v10 offset:49152
  v_mfma_f32_32x32x16_bf16 v[80:95], a[28:31], v[184:187], v[80:95]
  buffer_load_dwordx4 v24, s[28:31], s70 offen lds
  s_addk_i32 m0, 1024
  s_addk_i32 s70, 4096
  ds_read_b128 v[224:227], v11 offset:49152
  ds_read_b128 v[228:231], v12 offset:49152
  v_mfma_f32_32x32x16_bf16 v[64:79], a[32:35], v[184:187], v[64:79]
  ds_read_b128 v[232:235], v13 offset:49152
  ds_read_b128 v[236:239], v14 offset:49152
  v_mfma_f32_32x32x16_bf16 v[80:95], a[32:35], v[188:191], v[80:95]
  buffer_load_dwordx4 v22, s[28:31], s70 offen lds
  s_waitcnt vmcnt(6)
  ds_read_b64_tr_b16 a[112:113], v25 offset:8192
  ds_read_b64_tr_b16 a[114:115], v25 offset:8448
  ds_read_b64_tr_b16 a[116:117], v25 offset:9216
  ds_read_b64_tr_b16 a[118:119], v25 offset:9472
  ds_read_b64_tr_b16 a[120:121], v25 offset:10240
  ds_read_b64_tr_b16 a[122:123], v25 offset:10496
  s_waitcnt lgkmcnt(12)
  v_mfma_f32_32x32x16_bf16 v[64:79], a[36:39], v[192:195], v[64:79]
  ds_read_b128 v[176:179], v26 offset:128
  ds_read_b128 v[180:183], v26 offset:5248
  v_mfma_f32_32x32x16_bf16 v[80:95], a[36:39], v[196:199], v[80:95]
  ds_read_b128 v[184:187], v26 offset:10368
  ds_read_b128 v[188:191], v26 offset:15488
  s_waitcnt lgkmcnt(4)
  s_addk_i32 m0, 1024
  s_nop 0
  buffer_load_dwordx4 v23, s[28:31], s70 offen lds
  v_mfma_f32_32x32x16_bf16 v[64:79], a[40:43], v[196:199], v[64:79]
  s_addk_i32 m0, 1024
  v_lshlrev_b32 v128, 16, v240
  v_and_b32 v129, s75, v240
  v_lshlrev_b32 v130, 16, v241
  v_and_b32 v131, s75, v241
  v_lshlrev_b32 v132, 16, v242
  v_mfma_f32_32x32x16_bf16 v[80:95], a[40:43], v[200:203], v[80:95]
  buffer_load_dwordx4 v24, s[28:31], s70 offen lds
  s_addk_i32 m0, 1024
  s_addk_i32 s70, 4096
  v_and_b32 v133, s75, v242
  v_lshlrev_b32 v134, 16, v243
  v_mfma_f32_32x32x16_bf16 v[64:79], a[44:47], v[200:203], v[64:79]
  v_and_b32 v135, s75, v243
  v_lshlrev_b32 v136, 16, v244
  v_and_b32 v137, s75, v244
  v_lshlrev_b32 v138, 16, v245
  v_and_b32 v139, s75, v245
  v_lshlrev_b32 v140, 16, v246
  v_mfma_f32_32x32x16_bf16 v[80:95], a[44:47], v[204:207], v[80:95]
  buffer_load_dwordx4 v22, s[28:31], s70 offen lds
  s_waitcnt vmcnt(6)
  ds_read_b64_tr_b16 a[124:125], v25 offset:11264
  ds_read_b64_tr_b16 a[126:127], v25 offset:11520
  ds_read_b64_tr_b16 a[128:129], v25 offset:12288
  ds_read_b64_tr_b16 a[130:131], v25 offset:12544
  ds_read_b64_tr_b16 a[132:133], v25 offset:13312
  ds_read_b64_tr_b16 a[134:135], v25 offset:13568
  s_waitcnt lgkmcnt(6)
  v_mfma_f32_32x32x16_bf16 v[64:79], a[48:51], v[176:179], v[64:79]
  ds_read_b128 v[192:195], v26 offset:160
  ds_read_b128 v[196:199], v26 offset:5280
  v_and_b32 v141, s75, v246
  v_lshlrev_b32 v142, 16, v247
  v_and_b32 v143, s75, v247
  s_nop 1
  v_mfma_f32_32x32x16_bf16 v[128:143], v[32:35], v[208:211], v[128:143]
  v_mfma_f32_32x32x16_bf16 v[128:143], v[36:39], v[212:215], v[128:143]
  v_mfma_f32_32x32x16_bf16 v[128:143], v[40:43], v[216:219], v[128:143]
  v_mfma_f32_32x32x16_bf16 v[128:143], v[44:47], v[220:223], v[128:143]
  v_mfma_f32_32x32x16_bf16 v[128:143], v[48:51], v[224:227], v[128:143]
  v_mfma_f32_32x32x16_bf16 v[128:143], v[52:55], v[228:231], v[128:143]
  v_mfma_f32_32x32x16_bf16 v[128:143], v[56:59], v[232:235], v[128:143]
  v_mfma_f32_32x32x16_bf16 v[128:143], v[60:63], v[236:239], v[128:143]
  v_mfma_f32_32x32x16_bf16 v[80:95], a[48:51], v[180:183], v[80:95]
  ds_read_b128 v[200:203], v26 offset:10400
  ds_read_b128 v[204:207], v26 offset:15520
  s_waitcnt lgkmcnt(4)
  s_addk_i32 m0, 1024
  s_nop 0
  buffer_load_dwordx4 v23, s[28:31], s70 offen lds
  v_mfma_f32_32x32x16_bf16 v[64:79], a[52:55], v[180:183], v[64:79]
  s_addk_i32 m0, 1024
  s_nop 2
  v_add_f32 v208, v128, v129
  v_mul_f32 v209, v128, v128
  v_add_f32 v210, v130, v131
  v_mul_f32 v211, v129, v129
  v_fmac_f32 v209, v130, v130
  v_mfma_f32_32x32x16_bf16 v[80:95], a[52:55], v[184:187], v[80:95]
  buffer_load_dwordx4 v24, s[28:31], s70 offen lds
  s_addk_i32 m0, 1024
  s_addk_i32 s70, 4096
  v_fmac_f32 v211, v131, v131
  v_fmac_f32 v209, v132, v132
  v_mfma_f32_32x32x16_bf16 v[64:79], a[56:59], v[184:187], v[64:79]
  v_add_f32 v208, v132, v208
  v_fmac_f32 v211, v133, v133
  v_add_f32 v210, v133, v210
  v_fmac_f32 v209, v134, v134
  v_add_f32 v208, v134, v208
  v_fmac_f32 v211, v135, v135
  v_mfma_f32_32x32x16_bf16 v[80:95], a[56:59], v[188:191], v[80:95]
  buffer_load_dwordx4 v22, s[28:31], s70 offen lds
  s_waitcnt vmcnt(6)
  ds_read_b64_tr_b16 a[136:137], v25
  ds_read_b64_tr_b16 a[138:139], v25 offset:256
  ds_read_b64_tr_b16 a[140:141], v25 offset:1024
  ds_read_b64_tr_b16 a[142:143], v25 offset:1280
  ds_read_b64_tr_b16 a[144:145], v25 offset:2048
  ds_read_b64_tr_b16 a[146:147], v25 offset:2304
  s_waitcnt lgkmcnt(6)
  v_mfma_f32_32x32x16_bf16 v[64:79], a[60:63], v[192:195], v[64:79]
  ds_read_b128 v[176:179], v26 offset:192
  ds_read_b128 v[180:183], v26 offset:5312
  v_add_f32 v210, v135, v210
  v_fmac_f32 v209, v136, v136
  v_add_f32 v208, v136, v208
  v_fmac_f32 v211, v137, v137
  v_mfma_f32_32x32x16_bf16 v[80:95], a[60:63], v[196:199], v[80:95]
  ds_read_b128 v[184:187], v26 offset:10432
  ds_read_b128 v[188:191], v26 offset:15552
  s_waitcnt lgkmcnt(4)
  s_addk_i32 m0, 1024
  s_nop 0
  buffer_load_dwordx4 v23, s[28:31], s70 offen lds
  v_mfma_f32_32x32x16_bf16 v[64:79], a[64:67], v[196:199], v[64:79]
  s_addk_i32 m0, 1024
  v_add_f32 v210, v137, v210
  v_fmac_f32 v209, v138, v138
  v_add_f32 v208, v138, v208
  v_fmac_f32 v211, v139, v139
  v_add_f32 v210, v139, v210
  v_mfma_f32_32x32x16_bf16 v[80:95], a[64:67], v[200:203], v[80:95]
  buffer_load_dwordx4 v24, s[28:31], s70 offen lds
  s_addk_i32 m0, 1024
  s_addk_i32 s70, 4096
  v_fmac_f32 v209, v140, v140
  v_add_f32 v208, v140, v208
  v_mfma_f32_32x32x16_bf16 v[64:79], a[68:71], v[200:203], v[64:79]
  v_fmac_f32 v211, v141, v141
  v_add_f32 v210, v141, v210
  v_fmac_f32 v209, v142, v142
  v_add_f32 v208, v142, v208
  v_fmac_f32 v211, v143, v143
  v_add_f32 v210, v143, v210
  v_mfma_f32_32x32x16_bf16 v[80:95], a[68:71], v[204:207], v[80:95]
  buffer_load_dwordx4 v22, s[28:31], s70 offen lds
  s_waitcnt vmcnt(6)
  ds_read_b64_tr_b16 a[148:149], v25 offset:3072
  ds_read_b64_tr_b16 a[150:151], v25 offset:3328
  ds_read_b64_tr_b16 a[152:153], v25 offset:4096
  ds_read_b64_tr_b16 a[154:155], v25 offset:4352
  ds_read_b64_tr_b16 a[156:157], v25 offset:5120
  ds_read_b64_tr_b16 a[158:159], v25 offset:5376
  s_waitcnt lgkmcnt(6)
  v_mfma_f32_32x32x16_bf16 v[64:79], a[72:75], v[176:179], v[64:79]
  ds_read_b128 v[192:195], v26 offset:224
  ds_read_b128 v[196:199], v26 offset:5344
  v_add_f32 v208, v208, v210
  v_add_f32 v209, v209, v211
  s_nop 1
  v_permlane32_swap_b32 v208, v209
  v_add_f32 v208, v208, v209
  v_mfma_f32_32x32x16_bf16 v[80:95], a[72:75], v[180:183], v[80:95]
  ds_read_b128 v[200:203], v26 offset:10464
  ds_read_b128 v[204:207], v26 offset:15584
  s_waitcnt lgkmcnt(4)
  s_addk_i32 m0, 1024
  s_nop 0
  buffer_load_dwordx4 v23, s[28:31], s70 offen lds
  v_mfma_f32_32x32x16_bf16 v[64:79], a[76:79], v[180:183], v[64:79]
  s_addk_i32 m0, 1024
  ds_write_b32 v29, v208 offset:4096
  ds_read_b128 v[240:243], v15 offset:8192
  v_mfma_f32_32x32x16_bf16 v[80:95], a[76:79], v[184:187], v[80:95]
  buffer_load_dwordx4 v24, s[28:31], s70 offen lds
  s_addk_i32 m0, -13312
  s_addk_i32 s70, 4096
  ds_read_b128 v[244:247], v16 offset:8192
  ds_read_b128 v[208:211], v7 offset:57344
  v_mfma_f32_32x32x16_bf16 v[64:79], a[80:83], v[184:187], v[64:79]
  ds_read_b128 v[212:215], v8 offset:57344
  ds_read_b128 v[216:219], v9 offset:57344
  v_mfma_f32_32x32x16_bf16 v[80:95], a[80:83], v[188:191], v[80:95]
  buffer_load_dwordx4 v22, s[28:31], s70 offen lds
  s_waitcnt vmcnt(6)
  ds_read_b64_tr_b16 a[160:161], v25 offset:6144
  ds_read_b64_tr_b16 a[162:163], v25 offset:6400
  ds_read_b64_tr_b16 a[164:165], v25 offset:7168
  ds_read_b64_tr_b16 a[166:167], v25 offset:7424
  ds_read_b64_tr_b16 a[168:169], v25 offset:8192
  ds_read_b64_tr_b16 a[170:171], v25 offset:8448
  s_waitcnt lgkmcnt(12)
  v_mfma_f32_32x32x16_bf16 v[64:79], a[84:87], v[192:195], v[64:79]
  ds_read_b128 v[176:179], v26 offset:272
  ds_read_b128 v[180:183], v26 offset:5392
  v_mfma_f32_32x32x16_bf16 v[80:95], a[84:87], v[196:199], v[80:95]
  ds_read_b128 v[184:187], v26 offset:10512
  ds_read_b128 v[188:191], v26 offset:15632
  s_waitcnt lgkmcnt(4)
  s_addk_i32 m0, 1024
  s_nop 0
  buffer_load_dwordx4 v23, s[28:31], s70 offen lds
  v_mfma_f32_32x32x16_bf16 v[64:79], a[88:91], v[196:199], v[64:79]
  s_addk_i32 m0, 1024
  ds_read_b128 v[220:223], v10 offset:57344
  ds_read_b128 v[224:227], v11 offset:57344
  v_mfma_f32_32x32x16_bf16 v[80:95], a[88:91], v[200:203], v[80:95]
  buffer_load_dwordx4 v24, s[28:31], s70 offen lds
  s_addk_i32 m0, 1024
  s_addk_i32 s70, 4096
  ds_read_b128 v[228:231], v12 offset:57344
  ds_read_b128 v[232:235], v13 offset:57344
  v_mfma_f32_32x32x16_bf16 v[64:79], a[92:95], v[200:203], v[64:79]
  ds_read_b128 v[236:239], v14 offset:57344
  v_mfma_f32_32x32x16_bf16 v[80:95], a[92:95], v[204:207], v[80:95]
  buffer_load_dwordx4 v22, s[28:31], s70 offen lds
  s_waitcnt vmcnt(6)
  ds_read_b64_tr_b16 a[172:173], v25 offset:9216
  ds_read_b64_tr_b16 a[174:175], v25 offset:9472
  ds_read_b64_tr_b16 a[176:177], v25 offset:10240
  ds_read_b64_tr_b16 a[178:179], v25 offset:10496
  ds_read_b64_tr_b16 a[180:181], v25 offset:11264
  ds_read_b64_tr_b16 a[182:183], v25 offset:11520
  s_waitcnt lgkmcnt(11)
  v_mfma_f32_32x32x16_bf16 v[64:79], a[96:99], v[176:179], v[64:79]
  ds_read_b128 v[192:195], v26 offset:304
  ds_read_b128 v[196:199], v26 offset:5424
  v_mfma_f32_32x32x16_bf16 v[80:95], a[96:99], v[180:183], v[80:95]
  ds_read_b128 v[200:203], v26 offset:10544
  ds_read_b128 v[204:207], v26 offset:15664
  s_waitcnt lgkmcnt(4)
  s_addk_i32 m0, 1024
  s_nop 0
  buffer_load_dwordx4 v23, s[28:31], s70 offen lds
  v_mfma_f32_32x32x16_bf16 v[64:79], a[100:103], v[180:183], v[64:79]
  s_addk_i32 m0, 1024
  v_lshlrev_b32 v112, 16, v240
  v_and_b32 v113, s75, v240
  v_lshlrev_b32 v114, 16, v241
  v_and_b32 v115, s75, v241
  v_lshlrev_b32 v116, 16, v242
  v_mfma_f32_32x32x16_bf16 v[80:95], a[100:103], v[184:187], v[80:95]
  buffer_load_dwordx4 v24, s[28:31], s70 offen lds
  s_addk_i32 m0, 1024
  s_addk_i32 s70, 4096
  v_and_b32 v117, s75, v242
  v_lshlrev_b32 v118, 16, v243
  v_mfma_f32_32x32x16_bf16 v[64:79], a[104:107], v[184:187], v[64:79]
  v_and_b32 v119, s75, v243
  v_lshlrev_b32 v120, 16, v244
  v_and_b32 v121, s75, v244
  v_lshlrev_b32 v122, 16, v245
  v_and_b32 v123, s75, v245
  v_lshlrev_b32 v124, 16, v246
  v_mfma_f32_32x32x16_bf16 v[80:95], a[104:107], v[188:191], v[80:95]
  buffer_load_dwordx4 v22, s[28:31], s70 offen lds
  s_waitcnt vmcnt(6)
  ds_read_b64_tr_b16 a[184:185], v25 offset:12288
  ds_read_b64_tr_b16 a[186:187], v25 offset:12544
  ds_read_b64_tr_b16 a[188:189], v25 offset:13312
  ds_read_b64_tr_b16 a[190:191], v25 offset:13568
  ds_read_b64_tr_b16 a[192:193], v25
  ds_read_b64_tr_b16 a[194:195], v25 offset:256
  s_waitcnt lgkmcnt(6)
  v_mfma_f32_32x32x16_bf16 v[64:79], a[108:111], v[192:195], v[64:79]
  ds_read_b128 v[176:179], v26 offset:336
  ds_read_b128 v[180:183], v26 offset:5456
  v_and_b32 v125, s75, v246
  v_lshlrev_b32 v126, 16, v247
  v_and_b32 v127, s75, v247
  s_nop 1
  v_mfma_f32_32x32x16_bf16 v[112:127], v[32:35], v[208:211], v[112:127]
  v_mfma_f32_32x32x16_bf16 v[112:127], v[36:39], v[212:215], v[112:127]
  v_mfma_f32_32x32x16_bf16 v[112:127], v[40:43], v[216:219], v[112:127]
  v_mfma_f32_32x32x16_bf16 v[112:127], v[44:47], v[220:223], v[112:127]
  v_mfma_f32_32x32x16_bf16 v[112:127], v[48:51], v[224:227], v[112:127]
  v_mfma_f32_32x32x16_bf16 v[112:127], v[52:55], v[228:231], v[112:127]
  v_mfma_f32_32x32x16_bf16 v[112:127], v[56:59], v[232:235], v[112:127]
  v_mfma_f32_32x32x16_bf16 v[112:127], v[60:63], v[236:239], v[112:127]
  v_mfma_f32_32x32x16_bf16 v[80:95], a[108:111], v[196:199], v[80:95]
  ds_read_b128 v[184:187], v26 offset:10576
  ds_read_b128 v[188:191], v26 offset:15696
  s_waitcnt lgkmcnt(4)
  s_addk_i32 m0, 1024
  s_nop 0
  buffer_load_dwordx4 v23, s[28:31], s70 offen lds
  v_mfma_f32_32x32x16_bf16 v[64:79], a[112:115], v[196:199], v[64:79]
  s_addk_i32 m0, 1024
  s_nop 2
  v_add_f32 v208, v112, v113
  v_mul_f32 v209, v112, v112
  v_add_f32 v210, v114, v115
  v_mul_f32 v211, v113, v113
  v_fmac_f32 v209, v114, v114
  v_mfma_f32_32x32x16_bf16 v[80:95], a[112:115], v[200:203], v[80:95]
  buffer_load_dwordx4 v24, s[28:31], s70 offen lds
  s_addk_i32 m0, 1024
  s_addk_i32 s70, 4096
  v_fmac_f32 v211, v115, v115
  v_fmac_f32 v209, v116, v116
  v_mfma_f32_32x32x16_bf16 v[64:79], a[116:119], v[200:203], v[64:79]
  v_add_f32 v208, v116, v208
  v_fmac_f32 v211, v117, v117
  v_add_f32 v210, v117, v210
  v_fmac_f32 v209, v118, v118
  v_add_f32 v208, v118, v208
  v_fmac_f32 v211, v119, v119
  v_mfma_f32_32x32x16_bf16 v[80:95], a[116:119], v[204:207], v[80:95]
  buffer_load_dwordx4 v22, s[28:31], s70 offen lds
  s_waitcnt vmcnt(6)
  ds_read_b64_tr_b16 a[196:197], v25 offset:1024
  ds_read_b64_tr_b16 a[198:199], v25 offset:1280
  ds_read_b64_tr_b16 a[200:201], v25 offset:2048
  ds_read_b64_tr_b16 a[202:203], v25 offset:2304
  ds_read_b64_tr_b16 a[204:205], v25 offset:3072
  ds_read_b64_tr_b16 a[206:207], v25 offset:3328
  s_waitcnt lgkmcnt(6)
  v_mfma_f32_32x32x16_bf16 v[64:79], a[120:123], v[176:179], v[64:79]
  ds_read_b128 v[192:195], v26 offset:368
  ds_read_b128 v[196:199], v26 offset:5488
  v_add_f32 v210, v119, v210
  v_fmac_f32 v209, v120, v120
  v_add_f32 v208, v120, v208
  v_fmac_f32 v211, v121, v121
  v_mfma_f32_32x32x16_bf16 v[80:95], a[120:123], v[180:183], v[80:95]
  ds_read_b128 v[200:203], v26 offset:10608
  ds_read_b128 v[204:207], v26 offset:15728
  s_waitcnt lgkmcnt(4)
  s_addk_i32 m0, 1024
  s_nop 0
  buffer_load_dwordx4 v23, s[28:31], s70 offen lds
  v_mfma_f32_32x32x16_bf16 v[64:79], a[124:127], v[180:183], v[64:79]
  s_addk_i32 m0, 1024
  v_add_f32 v210, v121, v210
  v_fmac_f32 v209, v122, v122
  v_add_f32 v208, v122, v208
  v_fmac_f32 v211, v123, v123
  v_add_f32 v210, v123, v210
  v_mfma_f32_32x32x16_bf16 v[80:95], a[124:127], v[184:187], v[80:95]
  buffer_load_dwordx4 v24, s[28:31], s70 offen lds
  s_addk_i32 m0, 1024
  s_addk_i32 s70, 4096
  v_fmac_f32 v209, v124, v124
  v_add_f32 v208, v124, v208
  v_mfma_f32_32x32x16_bf16 v[64:79], a[128:131], v[184:187], v[64:79]
  v_fmac_f32 v211, v125, v125
  v_add_f32 v210, v125, v210
  v_fmac_f32 v209, v126, v126
  v_add_f32 v208, v126, v208
  v_fmac_f32 v211, v127, v127
  v_add_f32 v210, v127, v210
  v_mfma_f32_32x32x16_bf16 v[80:95], a[128:131], v[188:191], v[80:95]
  buffer_load_dwordx4 v22, s[28:31], s70 offen lds
  s_waitcnt vmcnt(6)
  ds_read_b64_tr_b16 a[208:209], v25 offset:4096
  ds_read_b64_tr_b16 a[210:211], v25 offset:4352
  ds_read_b64_tr_b16 a[212:213], v25 offset:5120
  ds_read_b64_tr_b16 a[214:215], v25 offset:5376
  ds_read_b64_tr_b16 a[216:217], v25 offset:6144
  ds_read_b64_tr_b16 a[218:219], v25 offset:6400
  s_waitcnt lgkmcnt(6)
  v_mfma_f32_32x32x16_bf16 v[64:79], a[132:135], v[192:195], v[64:79]
  ds_read_b128 v[176:179], v26 offset:400
  ds_read_b128 v[180:183], v26 offset:5520
  v_add_f32 v208, v208, v210
  v_add_f32 v209, v209, v211
  s_nop 1
  v_permlane32_swap_b32 v208, v209
  v_add_f32 v208, v208, v209
  v_mfma_f32_32x32x16_bf16 v[80:95], a[132:135], v[196:199], v[80:95]
  ds_read_b128 v[184:187], v26 offset:10640
  ds_read_b128 v[188:191], v26 offset:15760
  s_waitcnt lgkmcnt(4)
  s_addk_i32 m0, 1024
  s_nop 0
  buffer_load_dwordx4 v23, s[28:31], s70 offen lds
  v_mfma_f32_32x32x16_bf16 v[64:79], a[136:139], v[196:199], v[64:79]
  s_addk_i32 m0, -13312
  ds_write_b32 v29, v208 offset:5120
  v_mfma_f32_32x32x16_bf16 v[80:95], a[136:139], v[200:203], v[80:95]
  buffer_load_dwordx4 v24, s[28:31], s70 offen lds
  s_addk_i32 m0, 1024
  s_addk_i32 s70, 4096
  v_mfma_f32_32x32x16_bf16 v[64:79], a[140:143], v[200:203], v[64:79]
  v_mfma_f32_32x32x16_bf16 v[80:95], a[140:143], v[204:207], v[80:95]
  buffer_load_dwordx4 v22, s[28:31], s70 offen lds
  s_waitcnt vmcnt(6)
  ds_read_b64_tr_b16 a[220:221], v25 offset:7168
  ds_read_b64_tr_b16 a[222:223], v25 offset:7424
  ds_read_b64_tr_b16 a[224:225], v25 offset:8192
  ds_read_b64_tr_b16 a[226:227], v25 offset:8448
  ds_read_b64_tr_b16 a[228:229], v25 offset:9216
  ds_read_b64_tr_b16 a[230:231], v25 offset:9472
  s_waitcnt lgkmcnt(7)
  v_mfma_f32_32x32x16_bf16 v[64:79], a[144:147], v[176:179], v[64:79]
  ds_read_b128 v[192:195], v26 offset:432
  ds_read_b128 v[196:199], v26 offset:5552
  s_waitcnt lgkmcnt(8)
  s_barrier
  v_mfma_f32_32x32x16_bf16 v[80:95], a[144:147], v[180:183], v[80:95]
  ds_read_b128 v[200:203], v26 offset:10672
  ds_read_b128 v[204:207], v26 offset:15792
  s_waitcnt lgkmcnt(4)
  s_addk_i32 m0, 1024
  s_nop 0
  buffer_load_dwordx4 v23, s[28:31], s70 offen lds
  v_mfma_f32_32x32x16_bf16 v[64:79], a[148:151], v[180:183], v[64:79]
  s_addk_i32 m0, 1024
  ds_read_b128 v[232:235], v30 offset:4096
  ds_read_b128 v[236:239], v30 offset:4112
  v_mfma_f32_32x32x16_bf16 v[80:95], a[148:151], v[184:187], v[80:95]
  buffer_load_dwordx4 v24, s[28:31], s70 offen lds
  s_addk_i32 m0, 1024
  s_addk_i32 s70, 4096
  ds_read_b128 v[240:243], v30 offset:5120
  ds_read_b128 v[244:247], v30 offset:5136
  v_mfma_f32_32x32x16_bf16 v[64:79], a[152:155], v[184:187], v[64:79]
  v_cndmask_b32 v96, v96, v112, s[68:69]
  v_cndmask_b32 v97, v97, v113, s[68:69]
  v_cndmask_b32 v98, v98, v114, s[68:69]
  v_cndmask_b32 v99, v99, v115, s[68:69]
  v_cndmask_b32 v100, v100, v116, s[68:69]
  v_mfma_f32_32x32x16_bf16 v[80:95], a[152:155], v[188:191], v[80:95]
  buffer_load_dwordx4 v22, s[28:31], s70 offen lds
  s_waitcnt vmcnt(6)
  ds_read_b64_tr_b16 a[232:233], v25 offset:10240
  ds_read_b64_tr_b16 a[234:235], v25 offset:10496
  ds_read_b64_tr_b16 a[236:237], v25 offset:11264
  ds_read_b64_tr_b16 a[238:239], v25 offset:11520
  ds_read_b64_tr_b16 a[240:241], v25 offset:12288
  ds_read_b64_tr_b16 a[242:243], v25 offset:12544
  s_waitcnt lgkmcnt(10)
  v_mfma_f32_32x32x16_bf16 v[64:79], a[156:159], v[192:195], v[64:79]
  ds_read_b128 v[176:179], v26 offset:464
  ds_read_b128 v[180:183], v26 offset:5584
  v_cndmask_b32 v101, v101, v117, s[68:69]
  v_cndmask_b32 v102, v102, v118, s[68:69]
  v_cndmask_b32 v103, v103, v119, s[68:69]
  v_mfma_f32_32x32x16_bf16 v[80:95], a[156:159], v[196:199], v[80:95]
  ds_read_b128 v[184:187], v26 offset:10704
  ds_read_b128 v[188:191], v26 offset:15824
  s_waitcnt lgkmcnt(4)
  s_addk_i32 m0, 1024
  s_nop 0
  buffer_load_dwordx4 v23, s[28:31], s70 offen lds
  v_mfma_f32_32x32x16_bf16 v[64:79], a[160:163], v[196:199], v[64:79]
  s_addk_i32 m0, 1024
  v_cndmask_b32 v104, v104, v120, s[68:69]
  v_cndmask_b32 v105, v105, v121, s[68:69]
  v_cndmask_b32 v106, v106, v122, s[68:69]
  v_cndmask_b32 v107, v107, v123, s[68:69]
  v_mfma_f32_32x32x16_bf16 v[80:95], a[160:163], v[200:203], v[80:95]
  buffer_load_dwordx4 v24, s[28:31], s70 offen lds
  s_addk_i32 m0, 1024
  s_addk_i32 s70, 4096
  v_cndmask_b32 v108, v108, v124, s[68:69]
  v_cndmask_b32 v109, v109, v125, s[68:69]
  v_mfma_f32_32x32x16_bf16 v[64:79], a[164:167], v[200:203], v[64:79]
  v_cndmask_b32 v110, v110, v126, s[68:69]
  v_cndmask_b32 v111, v111, v127, s[68:69]
  v_add_f32 v232, v232, v234
  v_add_f32 v236, v236, v238
  v_add_f32 v233, v233, v235
  v_add_f32 v237, v237, v239
  v_mfma_f32_32x32x16_bf16 v[80:95], a[164:167], v[204:207], v[80:95]
  buffer_load_dwordx4 v22, s[28:31], s70 offen lds
  s_waitcnt vmcnt(6)
  ds_read_b64_tr_b16 a[244:245], v25 offset:13312
  ds_read_b64_tr_b16 a[246:247], v25 offset:13568
  ds_read_b64_tr_b16 a[248:249], v25
  ds_read_b64_tr_b16 a[250:251], v25 offset:256
  ds_read_b64_tr_b16 a[252:253], v25 offset:1024
  ds_read_b64_tr_b16 a[254:255], v25 offset:1280
  s_waitcnt lgkmcnt(6)
  v_mfma_f32_32x32x16_bf16 v[64:79], a[168:171], v[176:179], v[64:79]
  ds_read_b128 v[192:195], v26 offset:496
  ds_read_b128 v[196:199], v26 offset:5616
  v_add_f32 v232, v232, v236
  v_add_f32 v233, v233, v237
  v_mul_f32 v232, s72, v232
  v_mul_f32 v233, s72, v233
  v_mfma_f32_32x32x16_bf16 v[80:95], a[168:171], v[180:183], v[80:95]
  ds_read_b128 v[200:203], v26 offset:10736
  ds_read_b128 v[204:207], v26 offset:15856
  s_waitcnt lgkmcnt(4)
  s_addk_i32 m0, 1024
  s_nop 0
  buffer_load_dwordx4 v23, s[28:31], s70 offen lds
  v_mfma_f32_32x32x16_bf16 v[64:79], a[172:175], v[180:183], v[64:79]
  s_addk_i32 m0, 1024
  v_fma_f32 v233, -v232, v232, v233
  v_max_f32 v233, 0, v233
  v_add_f32 v233, 0x3727c5ac, v233
  v_rsq_f32 v234, v233
  v_mfma_f32_32x32x16_bf16 v[80:95], a[172:175], v[184:187], v[80:95]
  buffer_load_dwordx4 v24, s[28:31], s70 offen lds
  s_addk_i32 m0, 1024
  s_mov_b32 s70, 0
  v_mul_f32 v234, 0xbfb8aa3b, v234
  v_mul_f32_e64 v235, -v232, v234
  v_mfma_f32_32x32x16_bf16 v[64:79], a[176:179], v[184:187], v[64:79]
  v_fma_f32 v208, v128, v234, v235
  v_fma_f32 v209, v129, v234, v235
  v_fma_f32 v210, v130, v234, v235
  v_fma_f32 v211, v131, v234, v235
  v_fma_f32 v212, v132, v234, v235
  v_mfma_f32_32x32x16_bf16 v[80:95], a[176:179], v[188:191], v[80:95]
  buffer_load_dwordx4 v22, s[24:27], s70 offen lds
  s_waitcnt vmcnt(6)
  ds_read_b64_tr_b16 v[144:145], v25 offset:2048
  ds_read_b64_tr_b16 v[146:147], v25 offset:2304
  ds_read_b64_tr_b16 v[148:149], v25 offset:3072
  ds_read_b64_tr_b16 v[150:151], v25 offset:3328
  ds_read_b64_tr_b16 v[152:153], v25 offset:4096
  ds_read_b64_tr_b16 v[154:155], v25 offset:4352
  s_waitcnt lgkmcnt(6)
  v_mfma_f32_32x32x16_bf16 v[64:79], a[180:183], v[192:195], v[64:79]
  ds_read_b128 v[176:179], v26 offset:544
  ds_read_b128 v[180:183], v26 offset:5664
  v_fma_f32 v213, v133, v234, v235
  v_fma_f32 v214, v134, v234, v235
  v_fma_f32 v215, v135, v234, v235
  v_mfma_f32_32x32x16_bf16 v[80:95], a[180:183], v[196:199], v[80:95]
  ds_read_b128 v[184:187], v26 offset:10784
  ds_read_b128 v[188:191], v26 offset:15904
  s_waitcnt lgkmcnt(4)
  s_addk_i32 m0, 1024
  s_addk_i32 s70, 4096
  v_mfma_f32_32x32x16_bf16 v[64:79], a[184:187], v[196:199], v[64:79]
  buffer_load_dwordx4 v22, s[24:27], s70 offen lds
  s_addk_i32 m0, 1024
  s_addk_i32 s70, 4096
  v_exp_f32 v216, v208
  v_mfma_f32_32x32x16_bf16 v[80:95], a[184:187], v[200:203], v[80:95]
  v_exp_f32 v217, v209
  v_exp_f32 v218, v210
  v_exp_f32 v219, v211
  v_mfma_f32_32x32x16_bf16 v[64:79], a[188:191], v[200:203], v[64:79]
  buffer_load_dwordx4 v22, s[24:27], s70 offen lds
  s_addk_i32 m0, 1024
  s_addk_i32 s70, 4096
  v_exp_f32 v220, v212
  v_mfma_f32_32x32x16_bf16 v[80:95], a[188:191], v[204:207], v[80:95]
  v_exp_f32 v221, v213
  v_exp_f32 v222, v214
  v_exp_f32 v223, v215
  buffer_load_dwordx4 v22, s[24:27], s70 offen lds
  s_waitcnt vmcnt(6)
  ds_read_b64_tr_b16 v[156:157], v25 offset:5120
  ds_read_b64_tr_b16 v[158:159], v25 offset:5376
  ds_read_b64_tr_b16 v[160:161], v25 offset:6144
  ds_read_b64_tr_b16 v[162:163], v25 offset:6400
  ds_read_b64_tr_b16 v[164:165], v25 offset:7168
  ds_read_b64_tr_b16 v[166:167], v25 offset:7424
  s_waitcnt lgkmcnt(6)
  v_mfma_f32_32x32x16_bf16 v[64:79], a[192:195], v[176:179], v[64:79]
  ds_read_b128 v[192:195], v26 offset:576
  ds_read_b128 v[196:199], v26 offset:5696
  v_fma_f32 v216, v216, s66, s66
  v_fma_f32 v217, v217, s66, s66
  v_fma_f32 v218, v218, s66, s66
  v_mfma_f32_32x32x16_bf16 v[80:95], a[192:195], v[180:183], v[80:95]
  ds_read_b128 v[200:203], v26 offset:10816
  ds_read_b128 v[204:207], v26 offset:15936
  s_waitcnt lgkmcnt(4)
  s_addk_i32 m0, -13312
  s_addk_i32 s70, 4096
  v_fma_f32 v219, v219, s66, s66
  v_mfma_f32_32x32x16_bf16 v[64:79], a[196:199], v[180:183], v[64:79]
  buffer_load_dwordx4 v22, s[24:27], s70 offen lds
  s_addk_i32 m0, 1024
  s_addk_i32 s70, 4096
  v_fma_f32 v220, v220, s66, s66
  v_fma_f32 v221, v221, s66, s66
  v_mfma_f32_32x32x16_bf16 v[80:95], a[196:199], v[184:187], v[80:95]
  v_fma_f32 v222, v222, s66, s66
  v_fma_f32 v223, v223, s66, s66
  v_rcp_f32 v216, v216
  v_rcp_f32 v217, v217
  v_mfma_f32_32x32x16_bf16 v[64:79], a[200:203], v[184:187], v[64:79]
  buffer_load_dwordx4 v22, s[24:27], s70 offen lds
  s_addk_i32 m0, 1024
  s_addk_i32 s70, 4096
  v_rcp_f32 v218, v218
  v_mfma_f32_32x32x16_bf16 v[80:95], a[200:203], v[188:191], v[80:95]
  v_rcp_f32 v219, v219
  v_rcp_f32 v220, v220
  v_rcp_f32 v221, v221
  buffer_load_dwordx4 v22, s[24:27], s70 offen lds
  s_waitcnt vmcnt(7)
  ds_read_b64_tr_b16 v[168:169], v25 offset:8192
  ds_read_b64_tr_b16 v[170:171], v25 offset:8448
  ds_read_b64_tr_b16 v[172:173], v25 offset:9216
  ds_read_b64_tr_b16 v[174:175], v25 offset:9472
  s_waitcnt lgkmcnt(4)
  v_mfma_f32_32x32x16_bf16 v[64:79], a[204:207], v[192:195], v[64:79]
  ds_read_b128 v[176:179], v26 offset:608
  ds_read_b128 v[180:183], v26 offset:5728
  v_rcp_f32 v222, v222
  v_rcp_f32 v223, v223
  v_mfma_f32_32x32x16_bf16 v[80:95], a[204:207], v[196:199], v[80:95]
  ds_read_b128 v[184:187], v26 offset:10848
  ds_read_b128 v[188:191], v26 offset:15968
  s_waitcnt lgkmcnt(4)
  s_addk_i32 m0, 1024
  s_addk_i32 s70, 4096
  v_mul_f32 v208, v208, v216
  v_mfma_f32_32x32x16_bf16 v[64:79], a[208:211], v[196:199], v[64:79]
  buffer_load_dwordx4 v22, s[24:27], s70 offen lds
  v_mul_f32 v209, v209, v217
  v_mul_f32 v210, v210, v218
  v_mul_f32 v211, v211, v219
  v_mul_f32 v212, v212, v220
  v_mfma_f32_32x32x16_bf16 v[80:95], a[208:211], v[200:203], v[80:95]
  v_mul_f32 v213, v213, v221
  v_mul_f32 v214, v214, v222
  v_mul_f32 v215, v215, v223
  v_cvt_pk_bf16_f32 v224, v208, v209
  v_cvt_pk_bf16_f32 v225, v210, v211
  v_cvt_pk_bf16_f32 v226, v212, v213
  v_mfma_f32_32x32x16_bf16 v[64:79], a[212:215], v[200:203], v[64:79]
  v_cvt_pk_bf16_f32 v227, v214, v215
  v_fma_f32 v208, v136, v234, v235
  v_fma_f32 v209, v137, v234, v235
  v_fma_f32 v210, v138, v234, v235
  v_fma_f32 v211, v139, v234, v235
  v_mfma_f32_32x32x16_bf16 v[80:95], a[212:215], v[204:207], v[80:95]
  v_fma_f32 v212, v140, v234, v235
  v_fma_f32 v213, v141, v234, v235
  v_fma_f32 v214, v142, v234, v235
  v_fma_f32 v215, v143, v234, v235
  v_exp_f32 v216, v208
  s_waitcnt lgkmcnt(0)
  v_mfma_f32_32x32x16_bf16 v[64:79], a[216:219], v[176:179], v[64:79]
  ds_read_b128 v[192:195], v26 offset:640
  ds_read_b128 v[196:199], v26 offset:5760
  v_exp_f32 v217, v209
  v_exp_f32 v218, v210
  v_mfma_f32_32x32x16_bf16 v[80:95], a[216:219], v[180:183], v[80:95]
  ds_read_b128 v[200:203], v26 offset:10880
  ds_read_b128 v[204:207], v26 offset:16000
  v_exp_f32 v219, v211
  v_exp_f32 v220, v212
  v_mfma_f32_32x32x16_bf16 v[64:79], a[220:223], v[180:183], v[64:79]
  v_exp_f32 v221, v213
  v_exp_f32 v222, v214
  v_exp_f32 v223, v215
  v_mfma_f32_32x32x16_bf16 v[80:95], a[220:223], v[184:187], v[80:95]
  v_fma_f32 v216, v216, s66, s66
  v_fma_f32 v217, v217, s66, s66
  v_fma_f32 v218, v218, s66, s66
  v_fma_f32 v219, v219, s66, s66
  v_fma_f32 v220, v220, s66, s66
  v_mfma_f32_32x32x16_bf16 v[64:79], a[224:227], v[184:187], v[64:79]
  v_fma_f32 v221, v221, s66, s66
  v_fma_f32 v222, v222, s66, s66
  v_fma_f32 v223, v223, s66, s66
  v_rcp_f32 v216, v216
  v_mfma_f32_32x32x16_bf16 v[80:95], a[224:227], v[188:191], v[80:95]
  v_rcp_f32 v217, v217
  v_rcp_f32 v218, v218
  v_rcp_f32 v219, v219
  s_waitcnt lgkmcnt(0)
  v_mfma_f32_32x32x16_bf16 v[64:79], a[228:231], v[192:195], v[64:79]
  ds_read_b128 v[176:179], v26 offset:672
  ds_read_b128 v[180:183], v26 offset:5792
  v_rcp_f32 v220, v220
  v_rcp_f32 v221, v221
  v_mfma_f32_32x32x16_bf16 v[80:95], a[228:231], v[196:199], v[80:95]
  ds_read_b128 v[184:187], v26 offset:10912
  ds_read_b128 v[188:191], v26 offset:16032
  v_rcp_f32 v222, v222
  v_rcp_f32 v223, v223
  v_mfma_f32_32x32x16_bf16 v[64:79], a[232:235], v[196:199], v[64:79]
  v_mul_f32 v208, v208, v216
  v_mul_f32 v209, v209, v217
  v_mul_f32 v210, v210, v218
  v_mul_f32 v211, v211, v219
  v_mul_f32 v212, v212, v220
  v_mul_f32 v213, v213, v221
  v_mfma_f32_32x32x16_bf16 v[80:95], a[232:235], v[200:203], v[80:95]
  v_mul_f32 v214, v214, v222
  v_mul_f32 v215, v215, v223
  v_cvt_pk_bf16_f32 v228, v208, v209
  v_cvt_pk_bf16_f32 v229, v210, v211
  v_cvt_pk_bf16_f32 v230, v212, v213
  v_cvt_pk_bf16_f32 v231, v214, v215
  v_mfma_f32_32x32x16_bf16 v[64:79], a[236:239], v[200:203], v[64:79]
  ds_write_b128 v3, v[224:227] offset:30720
  ds_write_b128 v3, v[228:231] offset:30752
  v_mfma_f32_32x32x16_bf16 v[80:95], a[236:239], v[204:207], v[80:95]
  s_waitcnt lgkmcnt(2)
  v_mfma_f32_32x32x16_bf16 v[64:79], a[240:243], v[176:179], v[64:79]
  ds_read_b128 v[192:195], v26 offset:704
  ds_read_b128 v[196:199], v26 offset:5824
  v_mfma_f32_32x32x16_bf16 v[80:95], a[240:243], v[180:183], v[80:95]
  ds_read_b128 v[200:203], v26 offset:10944
  ds_read_b128 v[204:207], v26 offset:16064
  s_waitcnt vmcnt(5)
  v_mfma_f32_32x32x16_bf16 v[64:79], a[244:247], v[180:183], v[64:79]
  ds_read_b64_tr_b16 v[32:33], v25 offset:10240
  ds_read_b64_tr_b16 v[34:35], v25 offset:10496
  ds_read_b64_tr_b16 v[36:37], v25 offset:11264
  ds_read_b64_tr_b16 v[38:39], v25 offset:11520
  v_mfma_f32_32x32x16_bf16 v[80:95], a[244:247], v[184:187], v[80:95]
  ds_read_b64_tr_b16 v[40:41], v25 offset:12288
  ds_read_b64_tr_b16 v[42:43], v25 offset:12544
  v_mfma_f32_32x32x16_bf16 v[64:79], a[248:251], v[184:187], v[64:79]
  v_mfma_f32_32x32x16_bf16 v[80:95], a[248:251], v[188:191], v[80:95]
  s_waitcnt lgkmcnt(6)
  v_mfma_f32_32x32x16_bf16 v[64:79], a[252:255], v[192:195], v[64:79]
  ds_read_b128 v[176:179], v26 offset:736
  ds_read_b128 v[180:183], v26 offset:5856
  v_mfma_f32_32x32x16_bf16 v[80:95], a[252:255], v[196:199], v[80:95]
  ds_read_b128 v[184:187], v26 offset:10976
  ds_read_b128 v[188:191], v26 offset:16096
  s_waitcnt lgkmcnt(4)
  s_waitcnt vmcnt(2)
  v_mfma_f32_32x32x16_bf16 v[64:79], v[144:147], v[196:199], v[64:79]
  ds_read_b64_tr_b16 v[44:45], v25 offset:13312
  ds_read_b64_tr_b16 v[46:47], v25 offset:13568
  ds_read_b64_tr_b16 v[48:49], v25
  ds_read_b64_tr_b16 v[50:51], v25 offset:256
  v_mfma_f32_32x32x16_bf16 v[80:95], v[144:147], v[200:203], v[80:95]
  ds_read_b64_tr_b16 v[52:53], v25 offset:1024
  ds_read_b64_tr_b16 v[54:55], v25 offset:1280
  v_mfma_f32_32x32x16_bf16 v[64:79], v[148:151], v[200:203], v[64:79]
  v_mfma_f32_32x32x16_bf16 v[80:95], v[148:151], v[204:207], v[80:95]
  s_waitcnt lgkmcnt(6)
  v_mfma_f32_32x32x16_bf16 v[64:79], v[152:155], v[176:179], v[64:79]
  ds_read_b128 v[192:195], v26 offset:768
  ds_read_b128 v[196:199], v26 offset:5888
  v_mfma_f32_32x32x16_bf16 v[80:95], v[152:155], v[180:183], v[80:95]
  ds_read_b128 v[200:203], v26 offset:11008
  ds_read_b128 v[204:207], v26 offset:16128
  s_waitcnt lgkmcnt(4)
  s_waitcnt vmcnt(0)
  v_mfma_f32_32x32x16_bf16 v[64:79], v[156:159], v[180:183], v[64:79]
  ds_read_b64_tr_b16 v[56:57], v25 offset:2048
  ds_read_b64_tr_b16 v[58:59], v25 offset:2304
  ds_read_b64_tr_b16 v[60:61], v25 offset:3072
  ds_read_b64_tr_b16 v[62:63], v25 offset:3328
  v_mfma_f32_32x32x16_bf16 v[80:95], v[156:159], v[184:187], v[80:95]
  v_mfma_f32_32x32x16_bf16 v[64:79], v[160:163], v[184:187], v[64:79]
  v_mfma_f32_32x32x16_bf16 v[80:95], v[160:163], v[188:191], v[80:95]
  s_waitcnt lgkmcnt(4)
  v_mfma_f32_32x32x16_bf16 v[64:79], v[164:167], v[192:195], v[64:79]
  v_mfma_f32_32x32x16_bf16 v[80:95], v[164:167], v[196:199], v[80:95]
  s_waitcnt lgkmcnt(0)
  v_mfma_f32_32x32x16_bf16 v[64:79], v[168:171], v[196:199], v[64:79]
  v_mfma_f32_32x32x16_bf16 v[80:95], v[168:171], v[200:203], v[80:95]
  v_mfma_f32_32x32x16_bf16 v[64:79], v[172:175], v[200:203], v[64:79]
  v_mfma_f32_32x32x16_bf16 v[80:95], v[172:175], v[204:207], v[80:95]
  s_barrier
  ds_read_b128 v[176:179], v26 offset:20480
  ds_read_b128 v[180:183], v26 offset:30720
  ds_read_b128 v[184:187], v26 offset:20512
  ds_read_b128 v[188:191], v26 offset:30752
  s_waitcnt lgkmcnt(0)
  v_mfma_f32_32x32x16_bf16 v[96:111], a[0:3], v[176:179], v[96:111]
  ds_read_b128 v[192:195], v26 offset:20544
  ds_read_b128 v[196:199], v26 offset:30784
  s_add_u32 m0, s65, 0
  s_nop 0
  buffer_load_dwordx4 v1, s[8:11], s41 offen nt lds
  s_addk_i32 m0, 4096
  v_mfma_f32_32x32x16_bf16 v[96:111], a[8:11], v[180:183], v[96:111]
  ds_read_b128 v[200:203], v26 offset:20576
  ds_read_b128 v[204:207], v26 offset:30816
  v_mfma_f32_32x32x16_bf16 v[128:143], a[4:7], v[180:183], v[128:143]
  buffer_load_dwordx4 v1, s[8:11], s43 offen nt lds
  s_addk_i32 m0, 4096
  v_mfma_f32_32x32x16_bf16 v[96:111], a[12:15], v[184:187], v[96:111]
  v_mfma_f32_32x32x16_bf16 v[96:111], a[20:23], v[188:191], v[96:111]
  buffer_load_dwordx4 v1, s[8:11], s42 offen nt lds
  s_addk_i32 m0, 4096
  v_mfma_f32_32x32x16_bf16 v[128:143], a[16:19], v[188:191], v[128:143]
  s_waitcnt lgkmcnt(0)
  v_mfma_f32_32x32x16_bf16 v[96:111], a[24:27], v[192:195], v[96:111]
  ds_read_b128 v[176:179], v26 offset:20608
  ds_read_b128 v[180:183], v26 offset:30848
  buffer_load_dwordx4 v1, s[8:11], s44 offen nt lds
  s_add_u32 m0, s65, 0x14000
  v_mfma_f32_32x32x16_bf16 v[96:111], a[32:35], v[196:199], v[96:111]
  ds_read_b128 v[184:187], v26 offset:20640
  ds_read_b128 v[188:191], v26 offset:30880
  v_mfma_f32_32x32x16_bf16 v[128:143], a[28:31], v[196:199], v[128:143]
  buffer_load_dwordx4 v1, s[8:11], s45 offen nt lds
  s_addk_i32 m0, 4096
  v_mfma_f32_32x32x16_bf16 v[96:111], a[36:39], v[200:203], v[96:111]
  v_mfma_f32_32x32x16_bf16 v[96:111], a[44:47], v[204:207], v[96:111]
  buffer_load_dwordx4 v1, s[8:11], s47 offen nt lds
  s_addk_i32 m0, 4096
  v_mfma_f32_32x32x16_bf16 v[128:143], a[40:43], v[204:207], v[128:143]
  s_waitcnt lgkmcnt(0)
  v_mfma_f32_32x32x16_bf16 v[96:111], a[48:51], v[176:179], v[96:111]
  ds_read_b128 v[192:195], v26 offset:20672
  ds_read_b128 v[196:199], v26 offset:30912
  buffer_load_dwordx4 v1, s[8:11], s46 offen nt lds
  s_addk_i32 m0, 4096
  v_mfma_f32_32x32x16_bf16 v[96:111], a[56:59], v[180:183], v[96:111]
  ds_read_b128 v[200:203], v26 offset:20704
  ds_read_b128 v[204:207], v26 offset:30944
  v_mfma_f32_32x32x16_bf16 v[128:143], a[52:55], v[180:183], v[128:143]
  buffer_load_dwordx4 v1, s[8:11], s48 offen nt lds
  v_add_f32 v240, v240, v242
  v_add_f32 v244, v244, v246
  v_add_f32 v241, v241, v243
  v_add_f32 v245, v245, v247
  v_mfma_f32_32x32x16_bf16 v[96:111], a[60:63], v[184:187], v[96:111]
  v_add_f32 v240, v240, v244
  v_add_f32 v241, v241, v245
  v_mul_f32 v240, s72, v240
  v_mul_f32 v241, s72, v241
  v_fma_f32 v241, -v240, v240, v241
  v_max_f32 v241, 0, v241
  v_mfma_f32_32x32x16_bf16 v[96:111], a[68:71], v[188:191], v[96:111]
  v_add_f32 v241, 0x3727c5ac, v241
  v_rsq_f32 v242, v241
  s_nop 0
  v_mul_f32 v242, 0xbfb8aa3b, v242
  v_mul_f32_e64 v243, -v240, v242
  v_fma_f32 v208, v112, v242, v243
  v_mfma_f32_32x32x16_bf16 v[128:143], a[64:67], v[188:191], v[128:143]
  v_fma_f32 v209, v113, v242, v243
  v_fma_f32 v210, v114, v242, v243
  v_fma_f32 v211, v115, v242, v243
  v_fma_f32 v212, v116, v242, v243
  v_fma_f32 v213, v117, v242, v243
  s_waitcnt lgkmcnt(0)
  v_mfma_f32_32x32x16_bf16 v[96:111], a[72:75], v[192:195], v[96:111]
  ds_read_b128 v[176:179], v26 offset:20752
  ds_read_b128 v[180:183], v26 offset:30992
  v_fma_f32 v214, v118, v242, v243
  v_fma_f32 v215, v119, v242, v243
  v_exp_f32 v216, v208
  v_mfma_f32_32x32x16_bf16 v[96:111], a[80:83], v[196:199], v[96:111]
  ds_read_b128 v[184:187], v26 offset:20784
  ds_read_b128 v[188:191], v26 offset:31024
  v_exp_f32 v217, v209
  v_exp_f32 v218, v210
  v_mfma_f32_32x32x16_bf16 v[128:143], a[76:79], v[196:199], v[128:143]
  v_exp_f32 v219, v211
  v_exp_f32 v220, v212
  v_exp_f32 v221, v213
  v_mfma_f32_32x32x16_bf16 v[96:111], a[84:87], v[200:203], v[96:111]
  v_exp_f32 v222, v214
  v_exp_f32 v223, v215
  v_fma_f32 v216, v216, s66, s66
  v_fma_f32 v217, v217, s66, s66
  v_mfma_f32_32x32x16_bf16 v[96:111], a[92:95], v[204:207], v[96:111]
  v_fma_f32 v218, v218, s66, s66
  v_fma_f32 v219, v219, s66, s66
  v_fma_f32 v220, v220, s66, s66
  v_fma_f32 v221, v221, s66, s66
  v_fma_f32 v222, v222, s66, s66
  v_mfma_f32_32x32x16_bf16 v[128:143], a[88:91], v[204:207], v[128:143]
  v_fma_f32 v223, v223, s66, s66
  v_rcp_f32 v216, v216
  v_rcp_f32 v217, v217
  s_waitcnt lgkmcnt(0)
  v_mfma_f32_32x32x16_bf16 v[96:111], a[96:99], v[176:179], v[96:111]
  ds_read_b128 v[192:195], v26 offset:20816
  ds_read_b128 v[196:199], v26 offset:31056
  v_rcp_f32 v218, v218
  v_rcp_f32 v219, v219
  v_mfma_f32_32x32x16_bf16 v[96:111], a[104:107], v[180:183], v[96:111]
  ds_read_b128 v[200:203], v26 offset:20848
  ds_read_b128 v[204:207], v26 offset:31088
  v_rcp_f32 v220, v220
  v_rcp_f32 v221, v221
  v_mfma_f32_32x32x16_bf16 v[128:143], a[100:103], v[180:183], v[128:143]
  v_rcp_f32 v222, v222
  v_rcp_f32 v223, v223
  v_mul_f32 v208, v208, v216
  v_mul_f32 v209, v209, v217
  v_mfma_f32_32x32x16_bf16 v[96:111], a[108:111], v[184:187], v[96:111]
  v_mul_f32 v210, v210, v218
  v_mul_f32 v211, v211, v219
  v_mul_f32 v212, v212, v220
  v_mul_f32 v213, v213, v221
  v_mul_f32 v214, v214, v222
  v_mul_f32 v215, v215, v223
  v_mfma_f32_32x32x16_bf16 v[96:111], a[116:119], v[188:191], v[96:111]
  v_cvt_pk_bf16_f32 v224, v208, v209
  v_cvt_pk_bf16_f32 v225, v210, v211
  v_cvt_pk_bf16_f32 v226, v212, v213
  v_cvt_pk_bf16_f32 v227, v214, v215
  v_fma_f32 v208, v120, v242, v243
  v_mfma_f32_32x32x16_bf16 v[128:143], a[112:115], v[188:191], v[128:143]
  v_fma_f32 v209, v121, v242, v243
  v_fma_f32 v210, v122, v242, v243
  v_fma_f32 v211, v123, v242, v243
  v_fma_f32 v212, v124, v242, v243
  v_fma_f32 v213, v125, v242, v243
  s_waitcnt lgkmcnt(0)
  v_mfma_f32_32x32x16_bf16 v[96:111], a[120:123], v[192:195], v[96:111]
  ds_read_b128 v[176:179], v26 offset:20880
  ds_read_b128 v[180:183], v26 offset:31120
  v_fma_f32 v214, v126, v242, v243
  v_fma_f32 v215, v127, v242, v243
  v_exp_f32 v216, v208
  v_mfma_f32_32x32x16_bf16 v[96:111], a[128:131], v[196:199], v[96:111]
  ds_read_b128 v[184:187], v26 offset:20912
  ds_read_b128 v[188:191], v26 offset:31152
  v_exp_f32 v217, v209
  v_exp_f32 v218, v210
  v_mfma_f32_32x32x16_bf16 v[128:143], a[124:127], v[196:199], v[128:143]
  v_exp_f32 v219, v211
  v_exp_f32 v220, v212
  v_exp_f32 v221, v213
  v_mfma_f32_32x32x16_bf16 v[96:111], a[132:135], v[200:203], v[96:111]
  v_exp_f32 v222, v214
  v_exp_f32 v223, v215
  v_fma_f32 v216, v216, s66, s66
  v_fma_f32 v217, v217, s66, s66
  v_mfma_f32_32x32x16_bf16 v[96:111], a[140:143], v[204:207], v[96:111]
  v_fma_f32 v218, v218, s66, s66
  v_fma_f32 v219, v219, s66, s66
  v_fma_f32 v220, v220, s66, s66
  v_fma_f32 v221, v221, s66, s66
  v_fma_f32 v222, v222, s66, s66
  v_mfma_f32_32x32x16_bf16 v[128:143], a[136:139], v[204:207], v[128:143]
  v_fma_f32 v223, v223, s66, s66
  v_rcp_f32 v216, v216
  v_rcp_f32 v217, v217
  s_waitcnt lgkmcnt(0)
  v_mfma_f32_32x32x16_bf16 v[96:111], a[144:147], v[176:179], v[96:111]
  ds_read_b128 v[192:195], v26 offset:20944
  ds_read_b128 v[196:199], v26 offset:31184
  v_rcp_f32 v218, v218
  v_rcp_f32 v219, v219
  v_mfma_f32_32x32x16_bf16 v[96:111], a[152:155], v[180:183], v[96:111]
  ds_read_b128 v[200:203], v26 offset:20976
  ds_read_b128 v[204:207], v26 offset:31216
  v_rcp_f32 v220, v220
  v_rcp_f32 v221, v221
  v_mfma_f32_32x32x16_bf16 v[128:143], a[148:151], v[180:183], v[128:143]
  v_rcp_f32 v222, v222
  v_rcp_f32 v223, v223
  v_mul_f32 v208, v208, v216
  v_mul_f32 v209, v209, v217
  v_mfma_f32_32x32x16_bf16 v[96:111], a[156:159], v[184:187], v[96:111]
  v_mul_f32 v210, v210, v218
  v_mul_f32 v211, v211, v219
  v_mul_f32 v212, v212, v220
  v_mul_f32 v213, v213, v221
  v_mul_f32 v214, v214, v222
  v_mul_f32 v215, v215, v223
  v_mfma_f32_32x32x16_bf16 v[96:111], a[164:167], v[188:191], v[96:111]
  v_cvt_pk_bf16_f32 v228, v208, v209
  v_cvt_pk_bf16_f32 v229, v210, v211
  v_cvt_pk_bf16_f32 v230, v212, v213
  v_cvt_pk_bf16_f32 v231, v214, v215
  ds_write_b128 v5, v[224:227]
  v_mfma_f32_32x32x16_bf16 v[128:143], a[160:163], v[188:191], v[128:143]
  ds_write_b128 v5, v[228:231] offset:32
  v_cvt_pk_bf16_f32 v208, v64, v65
  v_cvt_pk_bf16_f32 v209, v66, v67
  v_cvt_pk_bf16_f32 v210, v68, v69
  v_cvt_pk_bf16_f32 v211, v70, v71
  s_waitcnt lgkmcnt(2)
  v_mfma_f32_32x32x16_bf16 v[96:111], a[168:171], v[192:195], v[96:111]
  ds_read_b128 v[176:179], v26 offset:21024
  ds_read_b128 v[180:183], v26 offset:31264
  v_cvt_pk_bf16_f32 v212, v72, v73
  v_cvt_pk_bf16_f32 v213, v74, v75
  v_cvt_pk_bf16_f32 v214, v76, v77
  v_mfma_f32_32x32x16_bf16 v[96:111], a[176:179], v[196:199], v[96:111]
  ds_read_b128 v[184:187], v26 offset:21056
  ds_read_b128 v[188:191], v26 offset:31296
  v_cvt_pk_bf16_f32 v215, v78, v79
  v_mfma_f32_32x32x16_bf16 v[128:143], a[172:175], v[196:199], v[128:143]
  ds_write_b128 v27, v[208:211]
  ds_write_b128 v27, v[212:215] offset:32
  v_cvt_pk_bf16_f32 v216, v80, v81
  v_cvt_pk_bf16_f32 v217, v82, v83
  v_mfma_f32_32x32x16_bf16 v[96:111], a[180:183], v[200:203], v[96:111]
  v_cvt_pk_bf16_f32 v218, v84, v85
  v_cvt_pk_bf16_f32 v219, v86, v87
  v_cvt_pk_bf16_f32 v220, v88, v89
  v_cvt_pk_bf16_f32 v221, v90, v91
  v_cvt_pk_bf16_f32 v222, v92, v93
  v_mfma_f32_32x32x16_bf16 v[96:111], a[188:191], v[204:207], v[96:111]
  v_cvt_pk_bf16_f32 v223, v94, v95
  ds_write_b128 v27, v[216:219] offset:8704
  ds_write_b128 v27, v[220:223] offset:8736
  v_mfma_f32_32x32x16_bf16 v[128:143], a[184:187], v[204:207], v[128:143]
  s_waitcnt lgkmcnt(4)
  v_mfma_f32_32x32x16_bf16 v[96:111], a[192:195], v[176:179], v[96:111]
  ds_read_b128 v[192:195], v26 offset:21088
  ds_read_b128 v[196:199], v26 offset:31328
  v_mfma_f32_32x32x16_bf16 v[96:111], a[200:203], v[180:183], v[96:111]
  ds_read_b128 v[200:203], v26 offset:21120
  ds_read_b128 v[204:207], v26 offset:31360
  v_mfma_f32_32x32x16_bf16 v[128:143], a[196:199], v[180:183], v[128:143]
  v_mfma_f32_32x32x16_bf16 v[96:111], a[204:207], v[184:187], v[96:111]
  v_mfma_f32_32x32x16_bf16 v[96:111], a[212:215], v[188:191], v[96:111]
  v_mfma_f32_32x32x16_bf16 v[128:143], a[208:211], v[188:191], v[128:143]
  s_waitcnt lgkmcnt(0)
  v_mfma_f32_32x32x16_bf16 v[96:111], a[216:219], v[192:195], v[96:111]
  ds_read_b128 v[176:179], v26 offset:21152
  ds_read_b128 v[180:183], v26 offset:31392
  v_mfma_f32_32x32x16_bf16 v[96:111], a[224:227], v[196:199], v[96:111]
  ds_read_b128 v[184:187], v26 offset:21184
  ds_read_b128 v[188:191], v26 offset:31424
  v_mfma_f32_32x32x16_bf16 v[128:143], a[220:223], v[196:199], v[128:143]
  v_mfma_f32_32x32x16_bf16 v[96:111], a[228:231], v[200:203], v[96:111]
  v_mfma_f32_32x32x16_bf16 v[96:111], a[236:239], v[204:207], v[96:111]
  v_mfma_f32_32x32x16_bf16 v[128:143], a[232:235], v[204:207], v[128:143]
  s_waitcnt lgkmcnt(0)
  v_mfma_f32_32x32x16_bf16 v[96:111], a[240:243], v[176:179], v[96:111]
  ds_read_b128 v[192:195], v26 offset:21216
  ds_read_b128 v[196:199], v26 offset:31456
  v_mfma_f32_32x32x16_bf16 v[96:111], a[248:251], v[180:183], v[96:111]
  ds_read_b128 v[200:203], v26 offset:21248
  ds_read_b128 v[204:207], v26 offset:31488
  v_mfma_f32_32x32x16_bf16 v[128:143], a[244:247], v[180:183], v[128:143]
  v_mfma_f32_32x32x16_bf16 v[96:111], a[252:255], v[184:187], v[96:111]
  v_mfma_f32_32x32x16_bf16 v[96:111], v[148:151], v[188:191], v[96:111]
  v_mfma_f32_32x32x16_bf16 v[128:143], v[144:147], v[188:191], v[128:143]
  s_waitcnt lgkmcnt(0)
  v_mfma_f32_32x32x16_bf16 v[96:111], v[152:155], v[192:195], v[96:111]
  v_mfma_f32_32x32x16_bf16 v[96:111], v[160:163], v[196:199], v[96:111]
  v_mfma_f32_32x32x16_bf16 v[128:143], v[156:159], v[196:199], v[128:143]
  v_mfma_f32_32x32x16_bf16 v[96:111], v[164:167], v[200:203], v[96:111]
  v_mfma_f32_32x32x16_bf16 v[96:111], v[172:175], v[204:207], v[96:111]
  v_mfma_f32_32x32x16_bf16 v[128:143], v[168:171], v[204:207], v[128:143]
  s_waitcnt vmcnt(4)
  s_barrier
  ds_read_b128 v[176:179], v26 offset:25600
  ds_read_b128 v[180:183], v26 offset:35840
  ds_read_b128 v[184:187], v26 offset:25632
  ds_read_b128 v[188:191], v26 offset:35872
  s_waitcnt lgkmcnt(0)
  v_mfma_f32_32x32x16_bf16 v[96:111], a[4:7], v[176:179], v[96:111]
  ds_read_b128 v[192:195], v26 offset:25664
  ds_read_b128 v[196:199], v26 offset:35904
  v_mfma_f32_32x32x16_bf16 v[128:143], a[0:3], v[176:179], v[128:143]
  ds_read_b128 v[200:203], v26 offset:25696
  ds_read_b128 v[204:207], v26 offset:35936
  v_mfma_f32_32x32x16_bf16 v[128:143], a[8:11], v[180:183], v[128:143]
  ds_read_b128 v[240:243], v15
  ds_read_b128 v[244:247], v16
  v_mfma_f32_32x32x16_bf16 v[96:111], a[16:19], v[184:187], v[96:111]
  ds_read_b128 v[208:211], v28
  ds_read_b128 v[212:215], v28 offset:32
  v_mfma_f32_32x32x16_bf16 v[128:143], a[12:15], v[184:187], v[128:143]
  ds_read_b128 v[216:219], v28 offset:64
  ds_read_b128 v[220:223], v28 offset:96
  v_mfma_f32_32x32x16_bf16 v[128:143], a[20:23], v[188:191], v[128:143]
  ds_read_b128 v[224:227], v28 offset:128
  ds_read_b128 v[228:231], v28 offset:160
  s_waitcnt lgkmcnt(8)
  v_mfma_f32_32x32x16_bf16 v[96:111], a[28:31], v[192:195], v[96:111]
  ds_read_b128 v[176:179], v26 offset:25728
  ds_read_b128 v[180:183], v26 offset:35968
  v_mfma_f32_32x32x16_bf16 v[128:143], a[24:27], v[192:195], v[128:143]
  ds_read_b128 v[184:187], v26 offset:25760
  ds_read_b128 v[188:191], v26 offset:36000
  v_mfma_f32_32x32x16_bf16 v[128:143], a[32:35], v[196:199], v[128:143]
  ds_read_b128 v[232:235], v28 offset:192
  ds_read_b128 v[236:239], v28 offset:224
  v_mfma_f32_32x32x16_bf16 v[96:111], a[40:43], v[200:203], v[96:111]
  v_mfma_f32_32x32x16_bf16 v[128:143], a[36:39], v[200:203], v[128:143]
  v_mfma_f32_32x32x16_bf16 v[128:143], a[44:47], v[204:207], v[128:143]
  s_waitcnt lgkmcnt(2)
  v_mfma_f32_32x32x16_bf16 v[96:111], a[52:55], v[176:179], v[96:111]
  ds_read_b128 v[192:195], v26 offset:25792
  ds_read_b128 v[196:199], v26 offset:36032
  v_lshlrev_b32 v64, 16, v240
  v_and_b32 v65, s75, v240
  v_lshlrev_b32 v66, 16, v241
  v_and_b32 v67, s75, v241
  v_mfma_f32_32x32x16_bf16 v[128:143], a[48:51], v[176:179], v[128:143]
  ds_read_b128 v[200:203], v26 offset:25824
  ds_read_b128 v[204:207], v26 offset:36064
  v_lshlrev_b32 v68, 16, v242
  v_and_b32 v69, s75, v242
  v_lshlrev_b32 v70, 16, v243
  v_and_b32 v71, s75, v243
  v_mfma_f32_32x32x16_bf16 v[128:143], a[56:59], v[180:183], v[128:143]
  v_lshlrev_b32 v72, 16, v244
  v_and_b32 v73, s75, v244
  v_lshlrev_b32 v74, 16, v245
  v_and_b32 v75, s75, v245
  v_lshlrev_b32 v76, 16, v246
  v_and_b32 v77, s75, v246
  v_mfma_f32_32x32x16_bf16 v[96:111], a[64:67], v[184:187], v[96:111]
  v_lshlrev_b32 v78, 16, v247
  v_and_b32 v79, s75, v247
  s_nop 1
  v_mfma_f32_32x32x16_bf16 v[64:79], v[32:35], v[208:211], v[64:79]
  v_mfma_f32_32x32x16_bf16 v[64:79], v[36:39], v[212:215], v[64:79]
  v_mfma_f32_32x32x16_bf16 v[64:79], v[40:43], v[216:219], v[64:79]
  v_mfma_f32_32x32x16_bf16 v[64:79], v[44:47], v[220:223], v[64:79]
  v_mfma_f32_32x32x16_bf16 v[64:79], v[48:51], v[224:227], v[64:79]
  v_mfma_f32_32x32x16_bf16 v[64:79], v[52:55], v[228:231], v[64:79]
  s_waitcnt lgkmcnt(5)
  v_mfma_f32_32x32x16_bf16 v[64:79], v[56:59], v[232:235], v[64:79]
  s_waitcnt lgkmcnt(4)
  v_mfma_f32_32x32x16_bf16 v[64:79], v[60:63], v[236:239], v[64:79]
  v_mfma_f32_32x32x16_bf16 v[128:143], a[60:63], v[184:187], v[128:143]
  v_mfma_f32_32x32x16_bf16 v[128:143], a[68:71], v[188:191], v[128:143]
  s_nop 9
  v_cvt_pk_bf16_f32 v208, v64, v65
  v_cvt_pk_bf16_f32 v209, v66, v67
  v_cvt_pk_bf16_f32 v210, v68, v69
  v_cvt_pk_bf16_f32 v211, v70, v71
  v_cvt_pk_bf16_f32 v212, v72, v73
  s_waitcnt lgkmcnt(0)
  v_mfma_f32_32x32x16_bf16 v[96:111], a[76:79], v[192:195], v[96:111]
  ds_read_b128 v[176:179], v26 offset:25872
  ds_read_b128 v[180:183], v26 offset:36112
  v_cvt_pk_bf16_f32 v213, v74, v75
  v_cvt_pk_bf16_f32 v214, v76, v77
  v_cvt_pk_bf16_f32 v215, v78, v79
  v_mfma_f32_32x32x16_bf16 v[128:143], a[72:75], v[192:195], v[128:143]
  ds_read_b128 v[184:187], v26 offset:25904
  ds_read_b128 v[188:191], v26 offset:36144
  v_mfma_f32_32x32x16_bf16 v[128:143], a[80:83], v[196:199], v[128:143]
  ds_write_b128 v20, v[208:211]
  ds_write_b128 v21, v[212:215]
  v_mfma_f32_32x32x16_bf16 v[96:111], a[88:91], v[200:203], v[96:111]
  ds_read_b128 v[216:219], v19
  ds_read_b128 v[220:223], v19 offset:1024
  v_mfma_f32_32x32x16_bf16 v[128:143], a[84:87], v[200:203], v[128:143]
  v_mfma_f32_32x32x16_bf16 v[128:143], a[92:95], v[204:207], v[128:143]
  s_waitcnt lgkmcnt(4)
  v_mfma_f32_32x32x16_bf16 v[96:111], a[100:103], v[176:179], v[96:111]
  ds_read_b128 v[192:195], v26 offset:25936
  ds_read_b128 v[196:199], v26 offset:36176
  v_mfma_f32_32x32x16_bf16 v[128:143], a[96:99], v[176:179], v[128:143]
  ds_read_b128 v[200:203], v26 offset:25968
  ds_read_b128 v[204:207], v26 offset:36208
  s_waitcnt lgkmcnt(5)
  buffer_store_dwordx4 v[216:219], v2, s[32:35], s41 offen sc1
  v_mfma_f32_32x32x16_bf16 v[128:143], a[104:107], v[180:183], v[128:143]
  v_mfma_f32_32x32x16_bf16 v[96:111], a[112:115], v[184:187], v[96:111]
  s_waitcnt lgkmcnt(4)
  buffer_store_dwordx4 v[220:223], v2, s[32:35], s43 offen sc1
  ds_read_b128 v[240:243], v15 offset:8192
  ds_read_b128 v[244:247], v16 offset:8192
  v_mfma_f32_32x32x16_bf16 v[128:143], a[108:111], v[184:187], v[128:143]
  ds_read_b128 v[208:211], v28 offset:8704
  ds_read_b128 v[212:215], v28 offset:8736
  v_mfma_f32_32x32x16_bf16 v[128:143], a[116:119], v[188:191], v[128:143]
  ds_read_b128 v[216:219], v28 offset:8768
  ds_read_b128 v[220:223], v28 offset:8800
  s_waitcnt lgkmcnt(6)
  v_mfma_f32_32x32x16_bf16 v[96:111], a[124:127], v[192:195], v[96:111]
  ds_read_b128 v[176:179], v26 offset:26000
  ds_read_b128 v[180:183], v26 offset:36240
  v_mfma_f32_32x32x16_bf16 v[128:143], a[120:123], v[192:195], v[128:143]
  ds_read_b128 v[184:187], v26 offset:26032
  ds_read_b128 v[188:191], v26 offset:36272
  v_mfma_f32_32x32x16_bf16 v[128:143], a[128:131], v[196:199], v[128:143]
  ds_read_b128 v[224:227], v28 offset:8832
  ds_read_b128 v[228:231], v28 offset:8864
  v_mfma_f32_32x32x16_bf16 v[96:111], a[136:139], v[200:203], v[96:111]
  ds_read_b128 v[232:235], v28 offset:8896
  ds_read_b128 v[236:239], v28 offset:8928
  v_mfma_f32_32x32x16_bf16 v[128:143], a[132:135], v[200:203], v[128:143]
  v_mfma_f32_32x32x16_bf16 v[128:143], a[140:143], v[204:207], v[128:143]
  s_waitcnt lgkmcnt(4)
  v_mfma_f32_32x32x16_bf16 v[96:111], a[148:151], v[176:179], v[96:111]
  ds_read_b128 v[192:195], v26 offset:26064
  ds_read_b128 v[196:199], v26 offset:36304
  v_mfma_f32_32x32x16_bf16 v[128:143], a[144:147], v[176:179], v[128:143]
  ds_read_b128 v[200:203], v26 offset:26096
  ds_read_b128 v[204:207], v26 offset:36336
  v_lshlrev_b32 v80, 16, v240
  v_and_b32 v81, s75, v240
  v_lshlrev_b32 v82, 16, v241
  v_and_b32 v83, s75, v241
  v_mfma_f32_32x32x16_bf16 v[128:143], a[152:155], v[180:183], v[128:143]
  v_lshlrev_b32 v84, 16, v242
  v_and_b32 v85, s75, v242
  v_lshlrev_b32 v86, 16, v243
  v_and_b32 v87, s75, v243
  v_lshlrev_b32 v88, 16, v244
  v_and_b32 v89, s75, v244
  v_mfma_f32_32x32x16_bf16 v[96:111], a[160:163], v[184:187], v[96:111]
  v_lshlrev_b32 v90, 16, v245
  v_and_b32 v91, s75, v245
  v_lshlrev_b32 v92, 16, v246
  v_and_b32 v93, s75, v246
  v_lshlrev_b32 v94, 16, v247
  v_and_b32 v95, s75, v247
  s_nop 1
  v_mfma_f32_32x32x16_bf16 v[80:95], v[32:35], v[208:211], v[80:95]
  v_mfma_f32_32x32x16_bf16 v[80:95], v[36:39], v[212:215], v[80:95]
  v_mfma_f32_32x32x16_bf16 v[80:95], v[40:43], v[216:219], v[80:95]
  v_mfma_f32_32x32x16_bf16 v[80:95], v[44:47], v[220:223], v[80:95]
  s_waitcnt lgkmcnt(7)
  v_mfma_f32_32x32x16_bf16 v[80:95], v[48:51], v[224:227], v[80:95]
  s_waitcnt lgkmcnt(6)
  v_mfma_f32_32x32x16_bf16 v[80:95], v[52:55], v[228:231], v[80:95]
  s_waitcnt lgkmcnt(5)
  v_mfma_f32_32x32x16_bf16 v[80:95], v[56:59], v[232:235], v[80:95]
  s_waitcnt lgkmcnt(4)
  v_mfma_f32_32x32x16_bf16 v[80:95], v[60:63], v[236:239], v[80:95]
  v_mfma_f32_32x32x16_bf16 v[128:143], a[156:159], v[184:187], v[128:143]
  v_mfma_f32_32x32x16_bf16 v[128:143], a[164:167], v[188:191], v[128:143]
  s_nop 9
  v_cvt_pk_bf16_f32 v208, v80, v81
  v_cvt_pk_bf16_f32 v209, v82, v83
  v_cvt_pk_bf16_f32 v210, v84, v85
  v_cvt_pk_bf16_f32 v211, v86, v87
  v_cvt_pk_bf16_f32 v212, v88, v89
  s_waitcnt lgkmcnt(0)
  v_mfma_f32_32x32x16_bf16 v[96:111], a[172:175], v[192:195], v[96:111]
  ds_read_b128 v[176:179], v26 offset:26144
  ds_read_b128 v[180:183], v26 offset:36384
  v_cvt_pk_bf16_f32 v213, v90, v91
  v_cvt_pk_bf16_f32 v214, v92, v93
  v_cvt_pk_bf16_f32 v215, v94, v95
  v_mfma_f32_32x32x16_bf16 v[128:143], a[168:171], v[192:195], v[128:143]
  ds_read_b128 v[184:187], v26 offset:26176
  ds_read_b128 v[188:191], v26 offset:36416
  v_mfma_f32_32x32x16_bf16 v[128:143], a[176:179], v[196:199], v[128:143]
  ds_write_b128 v20, v[208:211] offset:2048
  ds_write_b128 v21, v[212:215] offset:2048
  v_mfma_f32_32x32x16_bf16 v[96:111], a[184:187], v[200:203], v[96:111]
  ds_read_b128 v[216:219], v19 offset:2048
  ds_read_b128 v[220:223], v19 offset:3072
  v_mfma_f32_32x32x16_bf16 v[128:143], a[180:183], v[200:203], v[128:143]
  v_mfma_f32_32x32x16_bf16 v[128:143], a[188:191], v[204:207], v[128:143]
  s_waitcnt lgkmcnt(4)
  v_mfma_f32_32x32x16_bf16 v[96:111], a[196:199], v[176:179], v[96:111]
  ds_read_b128 v[192:195], v26 offset:26208
  ds_read_b128 v[196:199], v26 offset:36448
  v_mfma_f32_32x32x16_bf16 v[128:143], a[192:195], v[176:179], v[128:143]
  ds_read_b128 v[200:203], v26 offset:26240
  ds_read_b128 v[204:207], v26 offset:36480
  s_waitcnt lgkmcnt(5)
  buffer_store_dwordx4 v[216:219], v2, s[32:35], s42 offen sc1
  v_mfma_f32_32x32x16_bf16 v[128:143], a[200:203], v[180:183], v[128:143]
  v_mfma_f32_32x32x16_bf16 v[96:111], a[208:211], v[184:187], v[96:111]
  s_waitcnt lgkmcnt(4)
  buffer_store_dwordx4 v[220:223], v2, s[32:35], s44 offen sc1
  v_mfma_f32_32x32x16_bf16 v[128:143], a[204:207], v[184:187], v[128:143]
  v_mfma_f32_32x32x16_bf16 v[128:143], a[212:215], v[188:191], v[128:143]
  s_waitcnt lgkmcnt(0)
  v_mfma_f32_32x32x16_bf16 v[96:111], a[220:223], v[192:195], v[96:111]
  ds_read_b128 v[176:179], v26 offset:26272
  ds_read_b128 v[180:183], v26 offset:36512
  v_mfma_f32_32x32x16_bf16 v[128:143], a[216:219], v[192:195], v[128:143]
  ds_read_b128 v[184:187], v26 offset:26304
  ds_read_b128 v[188:191], v26 offset:36544
  v_mfma_f32_32x32x16_bf16 v[128:143], a[224:227], v[196:199], v[128:143]
  v_mfma_f32_32x32x16_bf16 v[96:111], a[232:235], v[200:203], v[96:111]
  v_mfma_f32_32x32x16_bf16 v[128:143], a[228:231], v[200:203], v[128:143]
  v_mfma_f32_32x32x16_bf16 v[128:143], a[236:239], v[204:207], v[128:143]
  s_waitcnt lgkmcnt(0)
  v_mfma_f32_32x32x16_bf16 v[96:111], a[244:247], v[176:179], v[96:111]
  ds_read_b128 v[192:195], v26 offset:26336
  ds_read_b128 v[196:199], v26 offset:36576
  v_mfma_f32_32x32x16_bf16 v[128:143], a[240:243], v[176:179], v[128:143]
  ds_read_b128 v[200:203], v26 offset:26368
  ds_read_b128 v[204:207], v26 offset:36608
  v_mfma_f32_32x32x16_bf16 v[128:143], a[248:251], v[180:183], v[128:143]
  v_mfma_f32_32x32x16_bf16 v[96:111], v[144:147], v[184:187], v[96:111]
  v_mfma_f32_32x32x16_bf16 v[128:143], a[252:255], v[184:187], v[128:143]
  v_mfma_f32_32x32x16_bf16 v[128:143], v[148:151], v[188:191], v[128:143]
  s_waitcnt lgkmcnt(0)
  v_mfma_f32_32x32x16_bf16 v[96:111], v[156:159], v[192:195], v[96:111]
  v_mfma_f32_32x32x16_bf16 v[128:143], v[152:155], v[192:195], v[128:143]
  v_mfma_f32_32x32x16_bf16 v[128:143], v[160:163], v[196:199], v[128:143]
  v_mfma_f32_32x32x16_bf16 v[96:111], v[168:171], v[200:203], v[96:111]
  v_mfma_f32_32x32x16_bf16 v[128:143], v[164:167], v[200:203], v[128:143]
  v_mfma_f32_32x32x16_bf16 v[128:143], v[172:175], v[204:207], v[128:143]
  s_nop 9
  v_cvt_pk_bf16_f32 v208, v96, v97
  v_cvt_pk_bf16_f32 v209, v98, v99
  v_cvt_pk_bf16_f32 v210, v100, v101
  v_cvt_pk_bf16_f32 v211, v102, v103
  v_cvt_pk_bf16_f32 v212, v104, v105
  v_cvt_pk_bf16_f32 v213, v106, v107
  v_cvt_pk_bf16_f32 v214, v108, v109
  v_cvt_pk_bf16_f32 v215, v110, v111
  ds_write_b128 v27, v[208:211] offset:17408
  ds_write_b128 v27, v[212:215] offset:17440
  v_cvt_pk_bf16_f32 v216, v128, v129
  v_cvt_pk_bf16_f32 v217, v130, v131
  v_cvt_pk_bf16_f32 v218, v132, v133
  v_cvt_pk_bf16_f32 v219, v134, v135
  v_cvt_pk_bf16_f32 v220, v136, v137
  v_cvt_pk_bf16_f32 v221, v138, v139
  v_cvt_pk_bf16_f32 v222, v140, v141
  v_cvt_pk_bf16_f32 v223, v142, v143
  ds_write_b128 v27, v[216:219] offset:26112
  ds_write_b128 v27, v[220:223] offset:26144
  s_waitcnt vmcnt(4) lgkmcnt(0)
  s_barrier
  ds_read_b128 v[208:211], v17
  ds_read_b128 v[212:215], v18
  ds_read_b128 v[216:219], v28 offset:17408
  ds_read_b128 v[220:223], v28 offset:17440
  ds_read_b128 v[224:227], v28 offset:17472
  ds_read_b128 v[228:231], v28 offset:17504
  ds_read_b128 v[232:235], v28 offset:17536
  ds_read_b128 v[236:239], v28 offset:17568
  ds_read_b128 v[240:243], v28 offset:17600
  ds_read_b128 v[244:247], v28 offset:17632
  ds_read_b128 v[176:179], v17 offset:8192
  ds_read_b128 v[180:183], v18 offset:8192
  ds_read_b128 v[184:187], v28 offset:26112
  ds_read_b128 v[188:191], v28 offset:26144
  ds_read_b128 v[192:195], v28 offset:26176
  ds_read_b128 v[196:199], v28 offset:26208
  ds_read_b128 v[200:203], v28 offset:26240
  ds_read_b128 v[204:207], v28 offset:26272
  ds_read_b128 v[144:147], v28 offset:26304
  ds_read_b128 v[148:151], v28 offset:26336
  s_waitcnt lgkmcnt(15)
  v_lshlrev_b32 v96, 16, v208
  v_and_b32 v97, s75, v208
  v_lshlrev_b32 v98, 16, v209
  v_and_b32 v99, s75, v209
  v_lshlrev_b32 v100, 16, v210
  v_and_b32 v101, s75, v210
  v_lshlrev_b32 v102, 16, v211
  v_and_b32 v103, s75, v211
  v_lshlrev_b32 v104, 16, v212
  v_and_b32 v105, s75, v212
  v_lshlrev_b32 v106, 16, v213
  v_and_b32 v107, s75, v213
  v_lshlrev_b32 v108, 16, v214
  v_and_b32 v109, s75, v214
  v_lshlrev_b32 v110, 16, v215
  v_and_b32 v111, s75, v215
  s_nop 1
  v_mfma_f32_32x32x16_bf16 v[96:111], v[32:35], v[216:219], v[96:111]
  s_waitcnt lgkmcnt(9)
  v_lshlrev_b32 v128, 16, v176
  v_and_b32 v129, s75, v176
  v_lshlrev_b32 v130, 16, v177
  v_and_b32 v131, s75, v177
  v_lshlrev_b32 v132, 16, v178
  v_and_b32 v133, s75, v178
  v_mfma_f32_32x32x16_bf16 v[96:111], v[36:39], v[220:223], v[96:111]
  v_lshlrev_b32 v134, 16, v179
  v_and_b32 v135, s75, v179
  s_waitcnt lgkmcnt(8)
  v_lshlrev_b32 v136, 16, v180
  v_and_b32 v137, s75, v180
  v_lshlrev_b32 v138, 16, v181
  v_and_b32 v139, s75, v181
  v_mfma_f32_32x32x16_bf16 v[96:111], v[40:43], v[224:227], v[96:111]
  v_lshlrev_b32 v140, 16, v182
  v_and_b32 v141, s75, v182
  v_lshlrev_b32 v142, 16, v183
  v_and_b32 v143, s75, v183
  v_mfma_f32_32x32x16_bf16 v[96:111], v[44:47], v[228:231], v[96:111]
  v_mfma_f32_32x32x16_bf16 v[96:111], v[48:51], v[232:235], v[96:111]
  v_mfma_f32_32x32x16_bf16 v[96:111], v[52:55], v[236:239], v[96:111]
  v_mfma_f32_32x32x16_bf16 v[96:111], v[56:59], v[240:243], v[96:111]
  v_mfma_f32_32x32x16_bf16 v[96:111], v[60:63], v[244:247], v[96:111]
  s_waitcnt lgkmcnt(7)
  v_mfma_f32_32x32x16_bf16 v[128:143], v[32:35], v[184:187], v[128:143]
  s_waitcnt lgkmcnt(6)
  v_mfma_f32_32x32x16_bf16 v[128:143], v[36:39], v[188:191], v[128:143]
  s_waitcnt lgkmcnt(5)
  v_mfma_f32_32x32x16_bf16 v[128:143], v[40:43], v[192:195], v[128:143]
  s_nop 5
  v_cvt_pk_bf16_f32 v64, v96, v97
  v_cvt_pk_bf16_f32 v65, v98, v99
  v_cvt_pk_bf16_f32 v66, v100, v101
  v_cvt_pk_bf16_f32 v67, v102, v103
  v_cvt_pk_bf16_f32 v68, v104, v105
  s_waitcnt lgkmcnt(4)
  v_mfma_f32_32x32x16_bf16 v[128:143], v[44:47], v[196:199], v[128:143]
  v_cvt_pk_bf16_f32 v69, v106, v107
  v_cvt_pk_bf16_f32 v70, v108, v109
  v_cvt_pk_bf16_f32 v71, v110, v111
  ds_write_b128 v20, v[64:67]
  s_waitcnt lgkmcnt(4)
  v_mfma_f32_32x32x16_bf16 v[128:143], v[48:51], v[200:203], v[128:143]
  ds_write_b128 v21, v[68:71]
  ds_read_b128 v[72:75], v19
  s_waitcnt lgkmcnt(5)
  v_mfma_f32_32x32x16_bf16 v[128:143], v[52:55], v[204:207], v[128:143]
  ds_read_b128 v[76:79], v19 offset:1024
  s_waitcnt lgkmcnt(5)
  v_mfma_f32_32x32x16_bf16 v[128:143], v[56:59], v[144:147], v[128:143]
  s_waitcnt lgkmcnt(4)
  v_mfma_f32_32x32x16_bf16 v[128:143], v[60:63], v[148:151], v[128:143]
  s_waitcnt lgkmcnt(1)
  buffer_store_dwordx4 v[72:75], v2, s[32:35], s45 offen sc1
  s_waitcnt lgkmcnt(0)
  buffer_store_dwordx4 v[76:79], v2, s[32:35], s47 offen sc1
  s_nop 7
  v_cvt_pk_bf16_f32 v80, v128, v129
  v_cvt_pk_bf16_f32 v81, v130, v131
  v_cvt_pk_bf16_f32 v82, v132, v133
  v_cvt_pk_bf16_f32 v83, v134, v135
  v_cvt_pk_bf16_f32 v84, v136, v137
  v_cvt_pk_bf16_f32 v85, v138, v139
  v_cvt_pk_bf16_f32 v86, v140, v141
  v_cvt_pk_bf16_f32 v87, v142, v143
  ds_write_b128 v20, v[80:83] offset:2048
  ds_write_b128 v21, v[84:87] offset:2048
  ds_read_b128 v[88:91], v19 offset:2048
  ds_read_b128 v[92:95], v19 offset:3072
  s_waitcnt lgkmcnt(1)
  buffer_store_dwordx4 v[88:91], v2, s[32:35], s46 offen sc1
  s_waitcnt lgkmcnt(0)
  buffer_store_dwordx4 v[92:95], v2, s[32:35], s48 offen sc1
L_end:
  s_endpgm
.section .rodata,"a"
.p2align 6
.amdhsa_kernel standalone__controlnet__diffusion_kernel
  .amdhsa_next_free_vgpr 512
  .amdhsa_next_free_sgpr 102
  .amdhsa_accum_offset 256
  .amdhsa_group_segment_fixed_size 0
  .amdhsa_kernarg_size 72
  .amdhsa_user_sgpr_count 2
  .amdhsa_user_sgpr_kernarg_segment_ptr 1
  .amdhsa_system_sgpr_workgroup_id_x 1
.end_amdhsa_kernel
```
